```python
import torch

def _softmax(x, axis=-1):
    return torch.softmax(x, dim=axis)
def _gelu(x):
    return torch.nn.functional.gelu(x, approximate="tanh")
def _silu(x):
    return torch.nn.functional.silu(x)
def _sigmoid(x):
    return torch.sigmoid(x)
def _layernorm(x, axis=-1, eps=1e-5):
    m = x.mean(dim=axis, keepdim=True)
    v = x.var(dim=axis, keepdim=True, unbiased=False)
    return (x - m) / torch.sqrt(v + eps)
def _scatter_add(tgt, idx, src, axis=0):
    return tgt.clone().index_add_(axis, idx, src)
def _segment_sum(src, seg, n):
    out = torch.zeros((n,) + src.shape[1:], dtype=src.dtype)
    return out.index_add_(0, seg, src)
def _pad(x, pw):
    flat = tuple(v for pair in reversed(pw) for v in pair)
    return torch.nn.functional.pad(x, flat)

kernel_name = 'concat_heads__gqa_block_cached__gqa_block_cached__decode'

def setup_inputs():

    _w = (lambda a: (lambda t: t.to(torch.bfloat16) if t.is_floating_point() else t)(torch.as_tensor(a)))
    def _A_setup():
        B, Sq, D = 2, 1, 640
        Hq, Hkv, Sk, Dh = 32, 32, 4096, 128
        assert Hq % Hkv == 0, (Hq, Hkv)
        return {
            "x": _w((lambda *s: torch.randn(*s, dtype=torch.bfloat16) * 0.8)(B, Sq, D)),
            "k_cache": _w((lambda *s: torch.randn(*s, dtype=torch.bfloat16) * 0.8)(B, Hkv, Sk, Dh)),
            "v_cache": _w((lambda *s: torch.randn(*s, dtype=torch.bfloat16) * 0.05)(B, Hkv, Sk, Dh)),
            "wq": _w((lambda *s: torch.randn(*s, dtype=torch.bfloat16) * 0.8)(D, Hq * Dh) * (D ** -0.5)),
            "wo": _w((lambda *s: torch.randn(*s, dtype=torch.bfloat16) * 0.05)(Hq * Dh, D) * ((Hq * Dh) ** -0.5)),
        }
    _A_in = _A_setup()

    def _B_setup():
        B, Sq, D = 2, 1, 640
        Hq, Hkv, Sk, Dh = 32, 32, 4096, 128
        assert Hq % Hkv == 0, (Hq, Hkv)
        return {
            "x": _w((lambda *s: torch.randn(*s, dtype=torch.bfloat16) * 0.8)(B, Sq, D)),
            "k_cache": _w((lambda *s: torch.randn(*s, dtype=torch.bfloat16) * 0.8)(B, Hkv, Sk, Dh)),
            "v_cache": _w((lambda *s: torch.randn(*s, dtype=torch.bfloat16) * 0.05)(B, Hkv, Sk, Dh)),
            "wq": _w((lambda *s: torch.randn(*s, dtype=torch.bfloat16) * 0.8)(D, Hq * Dh) * (D ** -0.5)),
            "wo": _w((lambda *s: torch.randn(*s, dtype=torch.bfloat16) * 0.05)(Hq * Dh, D) * ((Hq * Dh) ** -0.5)),
        }
    _B_in = _B_setup()

    return {
        "A_x": _A_in["x"],
        "A_k_cache": _A_in["k_cache"],
        "A_v_cache": _A_in["v_cache"],
        "A_wq": _A_in["wq"],
        "A_wo": _A_in["wo"],
        "B_x": _B_in["x"],
        "B_k_cache": _B_in["k_cache"],
        "B_v_cache": _B_in["v_cache"],
        "B_wq": _B_in["wq"],
        "B_wo": _B_in["wo"],
    }

def reference(A_x, A_k_cache, A_v_cache, A_wq, A_wo, B_x, B_k_cache, B_v_cache, B_wq, B_wo):
    def _A_ref(x, k_cache, v_cache, wq, wo):
        B, Sq, D = x.shape
        Hq, Dh = 32, 128
        Hkv = k_cache.shape[1]
        rep = Hq // Hkv
        q = (lambda x, *d: x.permute(*d))((x @ wq).reshape(B, Sq, Hq, Dh), 0, 2, 1, 3)
        k = (lambda x, n, axis: torch.repeat_interleave(x, n, dim=axis))(k_cache, rep, axis=1)
        v = (lambda x, n, axis: torch.repeat_interleave(x, n, dim=axis))(v_cache, rep, axis=1)
        scores = torch.einsum("bhqd,bhkd->bhqk", q, k) * (Dh ** -0.5)
        p = _softmax(scores, axis=-1)
        o = torch.einsum("bhqk,bhkd->bhqd", p, v)
        return (lambda x, *d: x.permute(*d))(o, 0, 2, 1, 3).reshape(B, Sq, Hq * Dh) @ wo

    def _B_ref(x, k_cache, v_cache, wq, wo):
        B, Sq, D = x.shape
        Hq, Dh = 32, 128
        Hkv = k_cache.shape[1]
        rep = Hq // Hkv
        q = (lambda x, *d: x.permute(*d))((x @ wq).reshape(B, Sq, Hq, Dh), 0, 2, 1, 3)
        k = (lambda x, n, axis: torch.repeat_interleave(x, n, dim=axis))(k_cache, rep, axis=1)
        v = (lambda x, n, axis: torch.repeat_interleave(x, n, dim=axis))(v_cache, rep, axis=1)
        scores = torch.einsum("bhqd,bhkd->bhqk", q, k) * (Dh ** -0.5)
        p = _softmax(scores, axis=-1)
        o = torch.einsum("bhqk,bhkd->bhqd", p, v)
        return (lambda x, *d: x.permute(*d))(o, 0, 2, 1, 3).reshape(B, Sq, Hq * Dh) @ wo

    a = _A_ref(A_x, A_k_cache, A_v_cache, A_wq, A_wo)
    b = _B_ref(B_x, B_k_cache, B_v_cache, B_wq, B_wo)
    return torch.concatenate([a, b], axis=-1)
```

```asm
; @launch grid=(256,1,1) block=(512,1,1) lds=160768
.amdgcn_target "amdgcn-amd-amdhsa--gfx950"
.text
.globl concat_heads__gqa_block_cached__gqa_block_cached__decode_kernel
.p2align 8
.type concat_heads__gqa_block_cached__gqa_block_cached__decode_kernel,@function
concat_heads__gqa_block_cached__gqa_block_cached__decode_kernel:
  s_cmp_ge_u32 s2, 256
  s_cbranch_scc1 L_end
  s_load_dwordx16 s[4:19], s[0:1], 0
  s_load_dwordx8 s[20:27], s[0:1], 64
  s_load_dwordx2 s[28:29], s[0:1], 96
  v_lshrrev_b32 v12, 6, v0
  v_and_b32 v13, 63, v0
  v_readfirstlane_b32 s3, v12
  s_and_b32 s69, s2, 7
  s_lshr_b32 s70, s2, 3
  s_lshr_b32 s71, s70, 2
  s_bfe_u32 s72, s70, 0x10001
  s_and_b32 s73, s70, 1
  s_and_b32 s74, s69, 3
  s_lshl_b32 s74, s74, 3
  s_add_u32 s74, s74, s71
  s_lshr_b32 s75, s69, 2
  s_and_b32 s68, s3, 3
  v_lshlrev_b32 v1, 4, v13
  v_lshrrev_b32 v14, 4, v13
  v_and_b32 v15, 15, v13
  s_cmp_ge_u32 s3, 4
  s_cbranch_scc1 L_wt
  s_lshl_b32 s76, s72, 5
  s_add_u32 s76, s76, s74
  s_lshl_b32 s76, s76, 1
  s_add_u32 s76, s76, s73
  s_lshl_b32 s76, s76, 19
  s_mul_i32 s80, s70, 1
  s_mul_i32 s77, s69, 32
  s_add_u32 s80, s80, s77
  s_lshl_b32 s80, s80, 12
  s_and_b32 s80, s80, 0x7ffff
  s_lshl_b32 s77, s68, 10
  v_add_u32 v2, s77, v1
  s_mov_b32 s34, 0x80000
  s_mov_b32 s35, 0x20000
  s_mov_b32 s38, 0x80000
  s_mov_b32 s39, 0x20000
  s_mul_i32 s95, s68, 32768
  s_add_u32 s95, s95, 29696
  s_cmp_eq_u32 s75, 1
  s_waitcnt lgkmcnt(0)
  s_cselect_b32 s32, s16, s6
  s_cselect_b32 s33, s17, s7
  s_cselect_b32 s36, s18, s8
  s_cselect_b32 s37, s19, s9
  s_add_u32 s32, s32, s76
  s_addc_u32 s33, s33, 0
  s_add_u32 s36, s36, s76
  s_addc_u32 s37, s37, 0
  buffer_load_dwordx4 v[96:99], v2, s[32:35], s80 offen nt
  s_add_u32 s80, s80, 4096
  s_and_b32 s80, s80, 0x7ffff
  buffer_load_dwordx4 v[100:103], v2, s[32:35], s80 offen nt
  s_add_u32 s80, s80, 4096
  s_and_b32 s80, s80, 0x7ffff
  buffer_load_dwordx4 v[104:107], v2, s[32:35], s80 offen nt
  s_add_u32 s80, s80, 4096
  s_and_b32 s80, s80, 0x7ffff
  buffer_load_dwordx4 v[108:111], v2, s[32:35], s80 offen nt
  s_add_u32 s80, s80, 4096
  s_and_b32 s80, s80, 0x7ffff
  buffer_load_dwordx4 v[112:115], v2, s[32:35], s80 offen nt
  s_add_u32 s80, s80, 4096
  s_and_b32 s80, s80, 0x7ffff
  buffer_load_dwordx4 v[116:119], v2, s[32:35], s80 offen nt
  s_add_u32 s80, s80, 4096
  s_and_b32 s80, s80, 0x7ffff
  buffer_load_dwordx4 v[120:123], v2, s[32:35], s80 offen nt
  s_add_u32 s80, s80, 4096
  s_and_b32 s80, s80, 0x7ffff
  buffer_load_dwordx4 v[124:127], v2, s[32:35], s80 offen nt
  s_add_u32 s80, s80, 4096
  s_and_b32 s80, s80, 0x7ffff
  v_mov_b32 v12, 0xffff
  v_mov_b32 v13, 0xffff0000
  v_cmp_eq_u32 vcc, 0, v15
  s_nop 1
  v_cndmask_b32 v4, 0, v12, vcc
  v_cmp_eq_u32 vcc, 1, v15
  s_nop 1
  v_cndmask_b32 v4, v4, v13, vcc
  v_cmp_eq_u32 vcc, 2, v15
  s_nop 1
  v_cndmask_b32 v5, 0, v12, vcc
  v_cmp_eq_u32 vcc, 3, v15
  s_nop 1
  v_cndmask_b32 v5, v5, v13, vcc
  v_cmp_eq_u32 vcc, 4, v15
  s_nop 1
  v_cndmask_b32 v6, 0, v12, vcc
  v_cmp_eq_u32 vcc, 5, v15
  s_nop 1
  v_cndmask_b32 v6, v6, v13, vcc
  v_cmp_eq_u32 vcc, 6, v15
  s_nop 1
  v_cndmask_b32 v7, 0, v12, vcc
  v_cmp_eq_u32 vcc, 7, v15
  s_nop 1
  v_cndmask_b32 v7, v7, v13, vcc
  v_lshrrev_b32 v12, 1, v14
  v_lshlrev_b32 v12, 9, v12
  v_lshl_add_u32 v12, v15, 5, v12
  v_and_b32 v13, 1, v14
  v_lshl_add_u32 v37, v13, 4, v12
  s_lshl_b32 s77, s68, 10
  v_add_u32 v36, s77, v37
  v_mov_b32 v41, 0xff800000
  v_lshlrev_b32 v12, 5, v15
  v_add_u32 v40, s95, v1
  v_mov_b32 v13, 0
  s_barrier
  s_cmp_eq_u32 s75, 1
  s_cselect_b32 s77, s20, s10
  s_lshr_b32 s77, s77, 8
  s_add_u32 s77, s77, s74
  s_and_b32 s77, s77, 3
  s_cmp_eq_u32 s77, 1
  s_cselect_b64 vcc, -1, 0
  s_waitcnt vmcnt(7)
  buffer_load_dwordx4 v[128:131], v2, s[32:35], s80 offen nt
  s_add_u32 s80, s80, 4096
  s_and_b32 s80, s80, 0x7ffff
  s_waitcnt vmcnt(7)
  buffer_load_dwordx4 v[132:135], v2, s[32:35], s80 offen nt
  s_add_u32 s80, s80, 4096
  s_and_b32 s80, s80, 0x7ffff
  s_waitcnt vmcnt(7)
  buffer_load_dwordx4 v[136:139], v2, s[32:35], s80 offen nt
  s_add_u32 s80, s80, 4096
  s_and_b32 s80, s80, 0x7ffff
  s_waitcnt vmcnt(7)
  buffer_load_dwordx4 v[140:143], v2, s[32:35], s80 offen nt
  s_add_u32 s80, s80, 4096
  s_and_b32 s80, s80, 0x7ffff
  s_waitcnt vmcnt(7)
  buffer_load_dwordx4 v[144:147], v2, s[32:35], s80 offen nt
  s_add_u32 s80, s80, 4096
  s_and_b32 s80, s80, 0x7ffff
  s_waitcnt vmcnt(7)
  buffer_load_dwordx4 v[148:151], v2, s[32:35], s80 offen nt
  s_add_u32 s80, s80, 4096
  s_and_b32 s80, s80, 0x7ffff
  s_waitcnt vmcnt(7)
  buffer_load_dwordx4 v[152:155], v2, s[32:35], s80 offen nt
  s_add_u32 s80, s80, 4096
  s_and_b32 s80, s80, 0x7ffff
  s_waitcnt vmcnt(7)
  buffer_load_dwordx4 v[64:67], v2, s[32:35], s80 offen nt
  s_add_u32 s80, s80, 4096
  s_and_b32 s80, s80, 0x7ffff
  s_waitcnt vmcnt(7)
  buffer_load_dwordx4 v[156:159], v2, s[32:35], s80 offen nt
  s_add_u32 s80, s80, 4096
  s_and_b32 s80, s80, 0x7ffff
  s_waitcnt vmcnt(7)
  buffer_load_dwordx4 v[160:163], v2, s[32:35], s80 offen nt
  s_add_u32 s80, s80, 4096
  s_and_b32 s80, s80, 0x7ffff
  s_waitcnt vmcnt(7)
  buffer_load_dwordx4 v[164:167], v2, s[32:35], s80 offen nt
  s_add_u32 s80, s80, 4096
  s_and_b32 s80, s80, 0x7ffff
  s_waitcnt vmcnt(7)
  buffer_load_dwordx4 v[168:171], v2, s[32:35], s80 offen nt
  s_add_u32 s80, s80, 4096
  s_and_b32 s80, s80, 0x7ffff
  s_waitcnt vmcnt(7)
  buffer_load_dwordx4 v[172:175], v2, s[32:35], s80 offen nt
  s_add_u32 s80, s80, 4096
  s_and_b32 s80, s80, 0x7ffff
  s_waitcnt vmcnt(7)
  buffer_load_dwordx4 v[176:179], v2, s[32:35], s80 offen nt
  s_add_u32 s80, s80, 4096
  s_and_b32 s80, s80, 0x7ffff
  s_waitcnt vmcnt(7)
  buffer_load_dwordx4 v[180:183], v2, s[32:35], s80 offen nt
  s_add_u32 s80, s80, 4096
  s_and_b32 s80, s80, 0x7ffff
  s_waitcnt vmcnt(7)
  buffer_load_dwordx4 v[184:187], v2, s[32:35], s80 offen nt
  s_add_u32 s80, s80, 4096
  s_and_b32 s80, s80, 0x7ffff
  s_waitcnt vmcnt(7)
  buffer_load_dwordx4 v[188:191], v2, s[32:35], s80 offen nt
  s_add_u32 s80, s80, 4096
  s_and_b32 s80, s80, 0x7ffff
  s_waitcnt vmcnt(7)
  buffer_load_dwordx4 v[192:195], v2, s[32:35], s80 offen nt
  s_add_u32 s80, s80, 4096
  s_and_b32 s80, s80, 0x7ffff
  s_waitcnt vmcnt(7)
  buffer_load_dwordx4 v[196:199], v2, s[32:35], s80 offen nt
  s_add_u32 s80, s80, 4096
  s_and_b32 s80, s80, 0x7ffff
  s_waitcnt vmcnt(7)
  buffer_load_dwordx4 v[200:203], v2, s[32:35], s80 offen nt
  s_add_u32 s80, s80, 4096
  s_and_b32 s80, s80, 0x7ffff
  s_waitcnt vmcnt(7)
  buffer_load_dwordx4 v[204:207], v2, s[32:35], s80 offen nt
  s_add_u32 s80, s80, 4096
  s_and_b32 s80, s80, 0x7ffff
  s_waitcnt vmcnt(7)
  buffer_load_dwordx4 v[208:211], v2, s[32:35], s80 offen nt
  s_add_u32 s80, s80, 4096
  s_and_b32 s80, s80, 0x7ffff
  s_waitcnt vmcnt(7)
  buffer_load_dwordx4 v[212:215], v2, s[32:35], s80 offen nt
  s_add_u32 s80, s80, 4096
  s_and_b32 s80, s80, 0x7ffff
  s_waitcnt vmcnt(7)
  buffer_load_dwordx4 v[68:71], v2, s[32:35], s80 offen nt
  s_add_u32 s80, s80, 4096
  s_and_b32 s80, s80, 0x7ffff
  s_waitcnt vmcnt(7)
  buffer_load_dwordx4 v[216:219], v2, s[32:35], s80 offen nt
  s_add_u32 s80, s80, 4096
  s_and_b32 s80, s80, 0x7ffff
  s_waitcnt vmcnt(7)
  buffer_load_dwordx4 v[220:223], v2, s[32:35], s80 offen nt
  s_add_u32 s80, s80, 4096
  s_and_b32 s80, s80, 0x7ffff
  s_waitcnt vmcnt(7)
  buffer_load_dwordx4 v[224:227], v2, s[32:35], s80 offen nt
  s_add_u32 s80, s80, 4096
  s_and_b32 s80, s80, 0x7ffff
  s_waitcnt vmcnt(7)
  buffer_load_dwordx4 v[228:231], v2, s[32:35], s80 offen nt
  s_add_u32 s80, s80, 4096
  s_and_b32 s80, s80, 0x7ffff
  s_waitcnt vmcnt(7)
  buffer_load_dwordx4 v[232:235], v2, s[32:35], s80 offen nt
  s_add_u32 s80, s80, 4096
  s_and_b32 s80, s80, 0x7ffff
  s_waitcnt vmcnt(7)
  buffer_load_dwordx4 v[236:239], v2, s[32:35], s80 offen nt
  s_add_u32 s80, s80, 4096
  s_and_b32 s80, s80, 0x7ffff
  s_waitcnt vmcnt(7)
  buffer_load_dwordx4 v[240:243], v2, s[32:35], s80 offen nt
  s_add_u32 s80, s80, 4096
  s_and_b32 s80, s80, 0x7ffff
  s_waitcnt vmcnt(7)
  buffer_load_dwordx4 v[244:247], v2, s[32:35], s80 offen nt
  s_add_u32 s80, s80, 4096
  s_and_b32 s80, s80, 0x7ffff
  s_waitcnt vmcnt(7)
  buffer_load_dwordx4 v[248:251], v2, s[32:35], s80 offen nt
  s_add_u32 s80, s80, 4096
  s_and_b32 s80, s80, 0x7ffff
  s_waitcnt vmcnt(7)
  buffer_load_dwordx4 v[252:255], v2, s[32:35], s80 offen nt
  s_add_u32 s80, s80, 4096
  s_and_b32 s80, s80, 0x7ffff
  s_waitcnt vmcnt(7)
  buffer_load_dwordx4 v[72:75], v2, s[32:35], s80 offen nt
  s_add_u32 s80, s80, 4096
  s_and_b32 s80, s80, 0x7ffff
  s_waitcnt vmcnt(7)
  buffer_load_dwordx4 v[76:79], v2, s[32:35], s80 offen nt
  s_add_u32 s80, s80, 4096
  s_and_b32 s80, s80, 0x7ffff
  s_waitcnt vmcnt(7)
  buffer_load_dwordx4 v[80:83], v2, s[32:35], s80 offen nt
  s_add_u32 s80, s80, 4096
  s_and_b32 s80, s80, 0x7ffff
  s_waitcnt vmcnt(7)
  buffer_load_dwordx4 v[84:87], v2, s[32:35], s80 offen nt
  s_add_u32 s80, s80, 4096
  s_and_b32 s80, s80, 0x7ffff
  s_waitcnt vmcnt(7)
  buffer_load_dwordx4 v[88:91], v2, s[32:35], s80 offen nt
  s_add_u32 s80, s80, 4096
  s_and_b32 s80, s80, 0x7ffff
  s_waitcnt vmcnt(7)
  buffer_load_dwordx4 v[92:95], v2, s[32:35], s80 offen nt
  s_add_u32 s80, s80, 4096
  s_and_b32 s80, s80, 0x7ffff
  s_waitcnt vmcnt(7)
  s_add_u32 m0, s95, 0
  s_nop 0
  buffer_load_dwordx4 v2, s[32:35], s80 offen nt lds
  s_add_u32 s80, s80, 4096
  s_and_b32 s80, s80, 0x7ffff
  s_waitcnt vmcnt(7)
  s_add_u32 m0, s95, 1024
  s_nop 0
  buffer_load_dwordx4 v2, s[32:35], s80 offen nt lds
  s_add_u32 s80, s80, 4096
  s_and_b32 s80, s80, 0x7ffff
  s_waitcnt vmcnt(7)
  s_add_u32 m0, s95, 2048
  s_nop 0
  buffer_load_dwordx4 v2, s[32:35], s80 offen nt lds
  s_add_u32 s80, s80, 4096
  s_and_b32 s80, s80, 0x7ffff
  s_waitcnt vmcnt(7)
  s_add_u32 m0, s95, 3072
  s_nop 0
  buffer_load_dwordx4 v2, s[32:35], s80 offen nt lds
  s_add_u32 s80, s80, 4096
  s_and_b32 s80, s80, 0x7ffff
  s_waitcnt vmcnt(7)
  s_add_u32 m0, s95, 4096
  s_nop 0
  buffer_load_dwordx4 v2, s[32:35], s80 offen nt lds
  s_add_u32 s80, s80, 4096
  s_and_b32 s80, s80, 0x7ffff
  s_waitcnt vmcnt(7)
  s_add_u32 m0, s95, 5120
  s_nop 0
  buffer_load_dwordx4 v2, s[32:35], s80 offen nt lds
  s_add_u32 s80, s80, 4096
  s_and_b32 s80, s80, 0x7ffff
  s_waitcnt vmcnt(7)
  s_add_u32 m0, s95, 6144
  s_nop 0
  buffer_load_dwordx4 v2, s[32:35], s80 offen nt lds
  s_add_u32 s80, s80, 4096
  s_and_b32 s80, s80, 0x7ffff
  s_waitcnt vmcnt(7)
  s_add_u32 m0, s95, 7168
  s_nop 0
  buffer_load_dwordx4 v2, s[32:35], s80 offen nt lds
  s_add_u32 s80, s80, 4096
  s_and_b32 s80, s80, 0x7ffff
  s_waitcnt vmcnt(7)
  s_add_u32 m0, s95, 8192
  s_nop 0
  buffer_load_dwordx4 v2, s[32:35], s80 offen nt lds
  s_add_u32 s80, s80, 4096
  s_and_b32 s80, s80, 0x7ffff
  s_waitcnt vmcnt(7)
  s_add_u32 m0, s95, 9216
  s_nop 0
  buffer_load_dwordx4 v2, s[32:35], s80 offen nt lds
  s_add_u32 s80, s80, 4096
  s_and_b32 s80, s80, 0x7ffff
  s_waitcnt vmcnt(7)
  s_add_u32 m0, s95, 10240
  s_nop 0
  buffer_load_dwordx4 v2, s[32:35], s80 offen nt lds
  s_add_u32 s80, s80, 4096
  s_and_b32 s80, s80, 0x7ffff
  s_waitcnt vmcnt(7)
  s_add_u32 m0, s95, 11264
  s_nop 0
  buffer_load_dwordx4 v2, s[32:35], s80 offen nt lds
  s_add_u32 s80, s80, 4096
  s_and_b32 s80, s80, 0x7ffff
  s_waitcnt vmcnt(7)
  s_add_u32 m0, s95, 12288
  s_nop 0
  buffer_load_dwordx4 v2, s[32:35], s80 offen nt lds
  s_add_u32 s80, s80, 4096
  s_and_b32 s80, s80, 0x7ffff
  s_waitcnt vmcnt(7)
  s_add_u32 m0, s95, 13312
  s_nop 0
  buffer_load_dwordx4 v2, s[32:35], s80 offen nt lds
  s_add_u32 s80, s80, 4096
  s_and_b32 s80, s80, 0x7ffff
  s_waitcnt vmcnt(7)
  s_add_u32 m0, s95, 14336
  s_nop 0
  buffer_load_dwordx4 v2, s[32:35], s80 offen nt lds
  s_add_u32 s80, s80, 4096
  s_and_b32 s80, s80, 0x7ffff
  s_waitcnt vmcnt(7)
  s_add_u32 m0, s95, 15360
  s_nop 0
  buffer_load_dwordx4 v2, s[32:35], s80 offen nt lds
  s_add_u32 s80, s80, 4096
  s_and_b32 s80, s80, 0x7ffff
  s_waitcnt vmcnt(7)
  s_add_u32 m0, s95, 16384
  s_nop 0
  buffer_load_dwordx4 v2, s[32:35], s80 offen nt lds
  s_add_u32 s80, s80, 4096
  s_and_b32 s80, s80, 0x7ffff
  s_waitcnt vmcnt(7)
  s_add_u32 m0, s95, 17408
  s_nop 0
  buffer_load_dwordx4 v2, s[32:35], s80 offen nt lds
  s_add_u32 s80, s80, 4096
  s_and_b32 s80, s80, 0x7ffff
  s_waitcnt vmcnt(7)
  s_add_u32 m0, s95, 18432
  s_nop 0
  buffer_load_dwordx4 v2, s[32:35], s80 offen nt lds
  s_add_u32 s80, s80, 4096
  s_and_b32 s80, s80, 0x7ffff
  s_waitcnt vmcnt(7)
  s_add_u32 m0, s95, 19456
  s_nop 0
  buffer_load_dwordx4 v2, s[32:35], s80 offen nt lds
  s_add_u32 s80, s80, 4096
  s_and_b32 s80, s80, 0x7ffff
  s_waitcnt vmcnt(7)
  s_add_u32 m0, s95, 20480
  s_nop 0
  buffer_load_dwordx4 v2, s[32:35], s80 offen nt lds
  s_add_u32 s80, s80, 4096
  s_and_b32 s80, s80, 0x7ffff
  s_waitcnt vmcnt(7)
  s_add_u32 m0, s95, 21504
  s_nop 0
  buffer_load_dwordx4 v2, s[32:35], s80 offen nt lds
  s_add_u32 s80, s80, 4096
  s_and_b32 s80, s80, 0x7ffff
  s_waitcnt vmcnt(7)
  s_add_u32 m0, s95, 22528
  s_nop 0
  buffer_load_dwordx4 v2, s[32:35], s80 offen nt lds
  s_add_u32 s80, s80, 4096
  s_and_b32 s80, s80, 0x7ffff
  s_waitcnt vmcnt(7)
  s_add_u32 m0, s95, 23552
  s_nop 0
  buffer_load_dwordx4 v2, s[32:35], s80 offen nt lds
  s_add_u32 s80, s80, 4096
  s_and_b32 s80, s80, 0x7ffff
  s_waitcnt vmcnt(7)
  s_add_u32 m0, s95, 24576
  s_nop 0
  buffer_load_dwordx4 v2, s[32:35], s80 offen nt lds
  s_add_u32 s80, s80, 4096
  s_and_b32 s80, s80, 0x7ffff
  s_waitcnt vmcnt(7)
  s_add_u32 m0, s95, 25600
  s_nop 0
  buffer_load_dwordx4 v2, s[32:35], s80 offen nt lds
  s_add_u32 s80, s80, 4096
  s_and_b32 s80, s80, 0x7ffff
  s_waitcnt vmcnt(7)
  s_add_u32 m0, s95, 26624
  s_nop 0
  buffer_load_dwordx4 v2, s[32:35], s80 offen nt lds
  s_add_u32 s80, s80, 4096
  s_and_b32 s80, s80, 0x7ffff
  s_waitcnt vmcnt(7)
  s_add_u32 m0, s95, 27648
  s_nop 0
  buffer_load_dwordx4 v2, s[32:35], s80 offen nt lds
  s_add_u32 s80, s80, 4096
  s_and_b32 s80, s80, 0x7ffff
  s_waitcnt vmcnt(7)
  s_add_u32 m0, s95, 28672
  s_nop 0
  buffer_load_dwordx4 v2, s[32:35], s80 offen nt lds
  s_add_u32 s80, s80, 4096
  s_and_b32 s80, s80, 0x7ffff
  s_waitcnt vmcnt(7)
  s_add_u32 m0, s95, 29696
  s_nop 0
  buffer_load_dwordx4 v2, s[32:35], s80 offen nt lds
  s_add_u32 s80, s80, 4096
  s_and_b32 s80, s80, 0x7ffff
  s_waitcnt vmcnt(7)
  s_add_u32 m0, s95, 30720
  s_nop 0
  buffer_load_dwordx4 v2, s[32:35], s80 offen nt lds
  s_add_u32 s80, s80, 4096
  s_and_b32 s80, s80, 0x7ffff
  s_waitcnt vmcnt(7)
  s_add_u32 m0, s95, 31744
  s_nop 0
  buffer_load_dwordx4 v2, s[32:35], s80 offen nt lds
  s_add_u32 s80, s80, 4096
  s_and_b32 s80, s80, 0x7ffff
L_qw:
  ds_read_b32 v44, v13 offset:28704
  s_waitcnt lgkmcnt(0)
  v_readfirstlane_b32 s77, v44
  s_cmp_ge_u32 s77, 256
  s_cbranch_scc1 L_qok
  s_sleep 1
  s_branch L_qw
L_qok:
  ds_read_b128 v[48:51], v12 offset:0
  ds_read_b128 v[52:55], v12 offset:16
  ds_read_b128 v[56:59], v12 offset:1024
  ds_read_b128 v[60:63], v12 offset:1040
  ds_read_b128 v[16:19], v12 offset:2048
  ds_read_b128 v[20:23], v12 offset:2064
  ds_read_b128 v[24:27], v12 offset:3072
  ds_read_b128 v[28:31], v12 offset:3088
  s_waitcnt lgkmcnt(0)
  v_add_f32 v48, v48, v56
  v_add_f32 v16, v16, v24
  v_add_f32 v49, v49, v57
  v_add_f32 v17, v17, v25
  v_add_f32 v50, v50, v58
  v_add_f32 v18, v18, v26
  v_add_f32 v51, v51, v59
  v_add_f32 v19, v19, v27
  v_add_f32 v52, v52, v60
  v_add_f32 v20, v20, v28
  v_add_f32 v53, v53, v61
  v_add_f32 v21, v21, v29
  v_add_f32 v54, v54, v62
  v_add_f32 v22, v22, v30
  v_add_f32 v55, v55, v63
  v_add_f32 v23, v23, v31
  v_add_f32 v48, v48, v16
  v_add_f32 v49, v49, v17
  v_add_f32 v50, v50, v18
  v_add_f32 v51, v51, v19
  v_add_f32 v52, v52, v20
  v_add_f32 v53, v53, v21
  v_add_f32 v54, v54, v22
  v_add_f32 v55, v55, v23
  v_cvt_pk_bf16_f32 v8, v48, v49
  v_cvt_pk_bf16_f32 v9, v50, v51
  v_cvt_pk_bf16_f32 v10, v52, v53
  v_cvt_pk_bf16_f32 v11, v54, v55
  v_dot2_f32_bf16 v48, v96, v8, 0
  v_dot2_f32_bf16 v48, v97, v9, v48
  v_dot2_f32_bf16 v48, v98, v10, v48
  v_dot2_f32_bf16 v48, v99, v11, v48
  v_dot2_f32_bf16 v49, v100, v8, 0
  v_dot2_f32_bf16 v49, v101, v9, v49
  v_dot2_f32_bf16 v49, v102, v10, v49
  v_dot2_f32_bf16 v49, v103, v11, v49
  v_dot2_f32_bf16 v50, v104, v8, 0
  v_dot2_f32_bf16 v50, v105, v9, v50
  v_dot2_f32_bf16 v50, v106, v10, v50
  v_dot2_f32_bf16 v50, v107, v11, v50
  s_cbranch_vccnz L_h80
  s_waitcnt vmcnt(4)
L_h80:
  s_waitcnt vmcnt(7)
  buffer_load_dwordx4 v[96:99], v2, s[32:35], s80 offen nt
  s_add_u32 s80, s80, 4096
  s_and_b32 s80, s80, 0x7ffff
  v_dot2_f32_bf16 v51, v108, v8, 0
  v_dot2_f32_bf16 v51, v109, v9, v51
  v_dot2_f32_bf16 v51, v110, v10, v51
  v_dot2_f32_bf16 v51, v111, v11, v51
  s_cbranch_vccnz L_h81
  s_waitcnt vmcnt(4)
L_h81:
  s_waitcnt vmcnt(7)
  buffer_load_dwordx4 v[100:103], v2, s[32:35], s80 offen nt
  s_add_u32 s80, s80, 4096
  s_and_b32 s80, s80, 0x7ffff
  v_dot2_f32_bf16 v52, v112, v8, 0
  v_dot2_f32_bf16 v52, v113, v9, v52
  v_dot2_f32_bf16 v52, v114, v10, v52
  v_dot2_f32_bf16 v52, v115, v11, v52
  s_cbranch_vccnz L_h82
  s_waitcnt vmcnt(4)
L_h82:
  s_waitcnt vmcnt(7)
  buffer_load_dwordx4 v[104:107], v2, s[32:35], s80 offen nt
  s_add_u32 s80, s80, 4096
  s_and_b32 s80, s80, 0x7ffff
  v_dot2_f32_bf16 v53, v116, v8, 0
  v_dot2_f32_bf16 v53, v117, v9, v53
  v_dot2_f32_bf16 v53, v118, v10, v53
  v_dot2_f32_bf16 v53, v119, v11, v53
  s_cbranch_vccnz L_h83
  s_waitcnt vmcnt(4)
L_h83:
  s_waitcnt vmcnt(7)
  buffer_load_dwordx4 v[108:111], v2, s[32:35], s80 offen nt
  s_add_u32 s80, s80, 4096
  s_and_b32 s80, s80, 0x7ffff
  v_dot2_f32_bf16 v54, v120, v8, 0
  v_dot2_f32_bf16 v54, v121, v9, v54
  v_dot2_f32_bf16 v54, v122, v10, v54
  v_dot2_f32_bf16 v54, v123, v11, v54
  s_cbranch_vccnz L_h84
  s_waitcnt vmcnt(4)
L_h84:
  s_waitcnt vmcnt(7)
  buffer_load_dwordx4 v[112:115], v2, s[32:35], s80 offen nt
  s_add_u32 s80, s80, 4096
  s_and_b32 s80, s80, 0x7ffff
  v_dot2_f32_bf16 v55, v124, v8, 0
  v_dot2_f32_bf16 v55, v125, v9, v55
  v_dot2_f32_bf16 v55, v126, v10, v55
  v_dot2_f32_bf16 v55, v127, v11, v55
  s_cbranch_vccnz L_h85
  s_waitcnt vmcnt(4)
L_h85:
  s_waitcnt vmcnt(7)
  buffer_load_dwordx4 v[116:119], v2, s[32:35], s80 offen nt
  s_add_u32 s80, s80, 4096
  s_and_b32 s80, s80, 0x7ffff
  v_dot2_f32_bf16 v56, v128, v8, 0
  v_dot2_f32_bf16 v56, v129, v9, v56
  v_dot2_f32_bf16 v56, v130, v10, v56
  v_dot2_f32_bf16 v56, v131, v11, v56
  s_cbranch_vccnz L_h86
  s_waitcnt vmcnt(4)
L_h86:
  s_waitcnt vmcnt(7)
  buffer_load_dwordx4 v[120:123], v2, s[32:35], s80 offen nt
  s_add_u32 s80, s80, 4096
  s_and_b32 s80, s80, 0x7ffff
  v_dot2_f32_bf16 v57, v132, v8, 0
  v_dot2_f32_bf16 v57, v133, v9, v57
  v_dot2_f32_bf16 v57, v134, v10, v57
  v_dot2_f32_bf16 v57, v135, v11, v57
  s_cbranch_vccnz L_h87
  s_waitcnt vmcnt(4)
L_h87:
  s_waitcnt vmcnt(7)
  buffer_load_dwordx4 v[124:127], v2, s[32:35], s80 offen nt
  s_add_u32 s80, s80, 4096
  s_and_b32 s80, s80, 0x7ffff
  v_dot2_f32_bf16 v58, v136, v8, 0
  v_dot2_f32_bf16 v58, v137, v9, v58
  v_dot2_f32_bf16 v58, v138, v10, v58
  v_dot2_f32_bf16 v58, v139, v11, v58
  v_dot2_f32_bf16 v59, v140, v8, 0
  v_dot2_f32_bf16 v59, v141, v9, v59
  v_dot2_f32_bf16 v59, v142, v10, v59
  v_dot2_f32_bf16 v59, v143, v11, v59
  v_dot2_f32_bf16 v60, v144, v8, 0
  v_dot2_f32_bf16 v60, v145, v9, v60
  v_dot2_f32_bf16 v60, v146, v10, v60
  v_dot2_f32_bf16 v60, v147, v11, v60
  v_dot2_f32_bf16 v61, v148, v8, 0
  v_dot2_f32_bf16 v61, v149, v9, v61
  v_dot2_f32_bf16 v61, v150, v10, v61
  v_dot2_f32_bf16 v61, v151, v11, v61
  v_dot2_f32_bf16 v62, v152, v8, 0
  v_dot2_f32_bf16 v62, v153, v9, v62
  v_dot2_f32_bf16 v62, v154, v10, v62
  v_dot2_f32_bf16 v62, v155, v11, v62
  v_dot2_f32_bf16 v63, v64, v8, 0
  v_dot2_f32_bf16 v63, v65, v9, v63
  v_dot2_f32_bf16 v63, v66, v10, v63
  v_dot2_f32_bf16 v63, v67, v11, v63
  s_cbranch_vccnz L_h88
  s_waitcnt vmcnt(4)
L_h88:
  s_waitcnt vmcnt(7)
  buffer_load_dwordx4 v[128:131], v2, s[32:35], s80 offen nt
  s_add_u32 s80, s80, 4096
  s_and_b32 s80, s80, 0x7ffff
  v_add_f32_dpp v48, v48, v48 row_mirror row_mask:0xf bank_mask:0x3
  s_nop 1
  v_add_f32_dpp v48, v56, v56 row_mirror row_mask:0xf bank_mask:0xc
  v_add_f32_dpp v49, v49, v49 row_mirror row_mask:0xf bank_mask:0x3
  s_nop 1
  v_add_f32_dpp v49, v57, v57 row_mirror row_mask:0xf bank_mask:0xc
  v_add_f32_dpp v50, v50, v50 row_mirror row_mask:0xf bank_mask:0x3
  s_nop 1
  v_add_f32_dpp v50, v58, v58 row_mirror row_mask:0xf bank_mask:0xc
  v_add_f32_dpp v51, v51, v51 row_mirror row_mask:0xf bank_mask:0x3
  s_nop 1
  v_add_f32_dpp v51, v59, v59 row_mirror row_mask:0xf bank_mask:0xc
  v_add_f32_dpp v52, v52, v52 row_mirror row_mask:0xf bank_mask:0x3
  s_nop 1
  v_add_f32_dpp v52, v60, v60 row_mirror row_mask:0xf bank_mask:0xc
  v_add_f32_dpp v53, v53, v53 row_mirror row_mask:0xf bank_mask:0x3
  s_nop 1
  v_add_f32_dpp v53, v61, v61 row_mirror row_mask:0xf bank_mask:0xc
  v_add_f32_dpp v54, v54, v54 row_mirror row_mask:0xf bank_mask:0x3
  s_nop 1
  v_add_f32_dpp v54, v62, v62 row_mirror row_mask:0xf bank_mask:0xc
  v_add_f32_dpp v55, v55, v55 row_mirror row_mask:0xf bank_mask:0x3
  s_nop 1
  v_add_f32_dpp v55, v63, v63 row_mirror row_mask:0xf bank_mask:0xc
  v_add_f32_dpp v48, v48, v48 row_half_mirror row_mask:0xf bank_mask:0x5
  s_nop 1
  v_add_f32_dpp v48, v52, v52 row_half_mirror row_mask:0xf bank_mask:0xa
  v_add_f32_dpp v49, v49, v49 row_half_mirror row_mask:0xf bank_mask:0x5
  s_nop 1
  v_add_f32_dpp v49, v53, v53 row_half_mirror row_mask:0xf bank_mask:0xa
  v_add_f32_dpp v50, v50, v50 row_half_mirror row_mask:0xf bank_mask:0x5
  s_nop 1
  v_add_f32_dpp v50, v54, v54 row_half_mirror row_mask:0xf bank_mask:0xa
  v_add_f32_dpp v51, v51, v51 row_half_mirror row_mask:0xf bank_mask:0x5
  s_nop 1
  v_add_f32_dpp v51, v55, v55 row_half_mirror row_mask:0xf bank_mask:0xa
  v_add_f32_dpp v48, v48, v48 quad_perm:[2,3,0,1] row_mask:0xf bank_mask:0xf
  v_add_f32_dpp v49, v49, v49 quad_perm:[2,3,0,1] row_mask:0xf bank_mask:0xf
  v_add_f32_dpp v50, v50, v50 quad_perm:[2,3,0,1] row_mask:0xf bank_mask:0xf
  v_add_f32_dpp v51, v51, v51 quad_perm:[2,3,0,1] row_mask:0xf bank_mask:0xf
  v_add_f32_dpp v64, v48, v48 quad_perm:[1,0,3,2] row_mask:0xf bank_mask:0xf
  v_add_f32_dpp v65, v49, v49 quad_perm:[1,0,3,2] row_mask:0xf bank_mask:0xf
  v_add_f32_dpp v66, v50, v50 quad_perm:[1,0,3,2] row_mask:0xf bank_mask:0xf
  v_add_f32_dpp v67, v51, v51 quad_perm:[1,0,3,2] row_mask:0xf bank_mask:0xf
  v_cvt_pk_bf16_f32 v65, v64, v65
  v_cvt_pk_bf16_f32 v67, v66, v67
  v_lshlrev_b32 v64, 16, v65
  v_lshlrev_b32 v66, 16, v67
  v_and_b32 v65, 0xffff0000, v65
  v_and_b32 v67, 0xffff0000, v67
  v_mul_f32 v64, 0x3db504f3, v64
  v_mul_f32 v65, 0x3db504f3, v65
  v_mul_f32 v66, 0x3db504f3, v66
  v_mul_f32 v67, 0x3db504f3, v67
  v_cvt_pk_bf16_f32 v65, v64, v65
  v_cvt_pk_bf16_f32 v67, v66, v67
  v_lshlrev_b32 v64, 16, v65
  v_lshlrev_b32 v66, 16, v67
  v_and_b32 v65, 0xffff0000, v65
  v_and_b32 v67, 0xffff0000, v67
  v_max3_f32 v41, v41, v64, v65
  v_max3_f32 v41, v41, v66, v67
  v_dot2_f32_bf16 v48, v156, v8, 0
  v_dot2_f32_bf16 v48, v157, v9, v48
  v_dot2_f32_bf16 v48, v158, v10, v48
  v_dot2_f32_bf16 v48, v159, v11, v48
  v_dot2_f32_bf16 v49, v160, v8, 0
  v_dot2_f32_bf16 v49, v161, v9, v49
  v_dot2_f32_bf16 v49, v162, v10, v49
  v_dot2_f32_bf16 v49, v163, v11, v49
  v_dot2_f32_bf16 v50, v164, v8, 0
  v_dot2_f32_bf16 v50, v165, v9, v50
  v_dot2_f32_bf16 v50, v166, v10, v50
  v_dot2_f32_bf16 v50, v167, v11, v50
  v_dot2_f32_bf16 v51, v168, v8, 0
  v_dot2_f32_bf16 v51, v169, v9, v51
  v_dot2_f32_bf16 v51, v170, v10, v51
  v_dot2_f32_bf16 v51, v171, v11, v51
  v_dot2_f32_bf16 v52, v172, v8, 0
  v_dot2_f32_bf16 v52, v173, v9, v52
  v_dot2_f32_bf16 v52, v174, v10, v52
  v_dot2_f32_bf16 v52, v175, v11, v52
  v_dot2_f32_bf16 v53, v176, v8, 0
  v_dot2_f32_bf16 v53, v177, v9, v53
  v_dot2_f32_bf16 v53, v178, v10, v53
  v_dot2_f32_bf16 v53, v179, v11, v53
  s_cbranch_vccnz L_h89
  s_waitcnt vmcnt(4)
L_h89:
  s_waitcnt vmcnt(7)
  buffer_load_dwordx4 v[132:135], v2, s[32:35], s80 offen nt
  s_add_u32 s80, s80, 4096
  s_and_b32 s80, s80, 0x7ffff
  v_dot2_f32_bf16 v54, v180, v8, 0
  v_dot2_f32_bf16 v54, v181, v9, v54
  v_dot2_f32_bf16 v54, v182, v10, v54
  v_dot2_f32_bf16 v54, v183, v11, v54
  v_dot2_f32_bf16 v55, v184, v8, 0
  v_dot2_f32_bf16 v55, v185, v9, v55
  v_dot2_f32_bf16 v55, v186, v10, v55
  v_dot2_f32_bf16 v55, v187, v11, v55
  v_dot2_f32_bf16 v56, v188, v8, 0
  v_dot2_f32_bf16 v56, v189, v9, v56
  v_dot2_f32_bf16 v56, v190, v10, v56
  v_dot2_f32_bf16 v56, v191, v11, v56
  v_dot2_f32_bf16 v57, v192, v8, 0
  v_dot2_f32_bf16 v57, v193, v9, v57
  v_dot2_f32_bf16 v57, v194, v10, v57
  v_dot2_f32_bf16 v57, v195, v11, v57
  v_dot2_f32_bf16 v58, v196, v8, 0
  v_dot2_f32_bf16 v58, v197, v9, v58
  v_dot2_f32_bf16 v58, v198, v10, v58
  v_dot2_f32_bf16 v58, v199, v11, v58
  v_dot2_f32_bf16 v59, v200, v8, 0
  v_dot2_f32_bf16 v59, v201, v9, v59
  v_dot2_f32_bf16 v59, v202, v10, v59
  v_dot2_f32_bf16 v59, v203, v11, v59
  s_cbranch_vccnz L_h90
  s_waitcnt vmcnt(4)
L_h90:
  s_waitcnt vmcnt(7)
  buffer_load_dwordx4 v[136:139], v2, s[32:35], s80 offen nt
  s_add_u32 s80, s80, 4096
  s_and_b32 s80, s80, 0x7ffff
  v_dot2_f32_bf16 v60, v204, v8, 0
  v_dot2_f32_bf16 v60, v205, v9, v60
  v_dot2_f32_bf16 v60, v206, v10, v60
  v_dot2_f32_bf16 v60, v207, v11, v60
  v_dot2_f32_bf16 v61, v208, v8, 0
  v_dot2_f32_bf16 v61, v209, v9, v61
  v_dot2_f32_bf16 v61, v210, v10, v61
  v_dot2_f32_bf16 v61, v211, v11, v61
  v_dot2_f32_bf16 v62, v212, v8, 0
  v_dot2_f32_bf16 v62, v213, v9, v62
  v_dot2_f32_bf16 v62, v214, v10, v62
  v_dot2_f32_bf16 v62, v215, v11, v62
  v_dot2_f32_bf16 v63, v68, v8, 0
  v_dot2_f32_bf16 v63, v69, v9, v63
  v_dot2_f32_bf16 v63, v70, v10, v63
  v_dot2_f32_bf16 v63, v71, v11, v63
  v_add_f32_dpp v48, v48, v48 row_mirror row_mask:0xf bank_mask:0x3
  s_nop 1
  v_add_f32_dpp v48, v56, v56 row_mirror row_mask:0xf bank_mask:0xc
  v_add_f32_dpp v49, v49, v49 row_mirror row_mask:0xf bank_mask:0x3
  s_nop 1
  v_add_f32_dpp v49, v57, v57 row_mirror row_mask:0xf bank_mask:0xc
  v_add_f32_dpp v50, v50, v50 row_mirror row_mask:0xf bank_mask:0x3
  s_nop 1
  v_add_f32_dpp v50, v58, v58 row_mirror row_mask:0xf bank_mask:0xc
  v_add_f32_dpp v51, v51, v51 row_mirror row_mask:0xf bank_mask:0x3
  s_nop 1
  v_add_f32_dpp v51, v59, v59 row_mirror row_mask:0xf bank_mask:0xc
  v_add_f32_dpp v52, v52, v52 row_mirror row_mask:0xf bank_mask:0x3
  s_nop 1
  v_add_f32_dpp v52, v60, v60 row_mirror row_mask:0xf bank_mask:0xc
  v_add_f32_dpp v53, v53, v53 row_mirror row_mask:0xf bank_mask:0x3
  s_nop 1
  v_add_f32_dpp v53, v61, v61 row_mirror row_mask:0xf bank_mask:0xc
  v_add_f32_dpp v54, v54, v54 row_mirror row_mask:0xf bank_mask:0x3
  s_nop 1
  v_add_f32_dpp v54, v62, v62 row_mirror row_mask:0xf bank_mask:0xc
  v_add_f32_dpp v55, v55, v55 row_mirror row_mask:0xf bank_mask:0x3
  s_nop 1
  v_add_f32_dpp v55, v63, v63 row_mirror row_mask:0xf bank_mask:0xc
  v_add_f32_dpp v48, v48, v48 row_half_mirror row_mask:0xf bank_mask:0x5
  s_nop 1
  v_add_f32_dpp v48, v52, v52 row_half_mirror row_mask:0xf bank_mask:0xa
  v_add_f32_dpp v49, v49, v49 row_half_mirror row_mask:0xf bank_mask:0x5
  s_nop 1
  v_add_f32_dpp v49, v53, v53 row_half_mirror row_mask:0xf bank_mask:0xa
  v_add_f32_dpp v50, v50, v50 row_half_mirror row_mask:0xf bank_mask:0x5
  s_nop 1
  v_add_f32_dpp v50, v54, v54 row_half_mirror row_mask:0xf bank_mask:0xa
  v_add_f32_dpp v51, v51, v51 row_half_mirror row_mask:0xf bank_mask:0x5
  s_nop 1
  v_add_f32_dpp v51, v55, v55 row_half_mirror row_mask:0xf bank_mask:0xa
  v_add_f32_dpp v48, v48, v48 quad_perm:[2,3,0,1] row_mask:0xf bank_mask:0xf
  v_add_f32_dpp v49, v49, v49 quad_perm:[2,3,0,1] row_mask:0xf bank_mask:0xf
  v_add_f32_dpp v50, v50, v50 quad_perm:[2,3,0,1] row_mask:0xf bank_mask:0xf
  v_add_f32_dpp v51, v51, v51 quad_perm:[2,3,0,1] row_mask:0xf bank_mask:0xf
  v_add_f32_dpp v68, v48, v48 quad_perm:[1,0,3,2] row_mask:0xf bank_mask:0xf
  v_add_f32_dpp v69, v49, v49 quad_perm:[1,0,3,2] row_mask:0xf bank_mask:0xf
  v_add_f32_dpp v70, v50, v50 quad_perm:[1,0,3,2] row_mask:0xf bank_mask:0xf
  v_add_f32_dpp v71, v51, v51 quad_perm:[1,0,3,2] row_mask:0xf bank_mask:0xf
  v_cvt_pk_bf16_f32 v69, v68, v69
  v_cvt_pk_bf16_f32 v71, v70, v71
  v_lshlrev_b32 v68, 16, v69
  v_lshlrev_b32 v70, 16, v71
  v_and_b32 v69, 0xffff0000, v69
  v_and_b32 v71, 0xffff0000, v71
  v_mul_f32 v68, 0x3db504f3, v68
  v_mul_f32 v69, 0x3db504f3, v69
  v_mul_f32 v70, 0x3db504f3, v70
  v_mul_f32 v71, 0x3db504f3, v71
  v_cvt_pk_bf16_f32 v69, v68, v69
  v_cvt_pk_bf16_f32 v71, v70, v71
  v_lshlrev_b32 v68, 16, v69
  v_lshlrev_b32 v70, 16, v71
  v_and_b32 v69, 0xffff0000, v69
  v_and_b32 v71, 0xffff0000, v71
  v_max3_f32 v41, v41, v68, v69
  v_max3_f32 v41, v41, v70, v71
  v_dot2_f32_bf16 v48, v216, v8, 0
  v_dot2_f32_bf16 v48, v217, v9, v48
  v_dot2_f32_bf16 v48, v218, v10, v48
  v_dot2_f32_bf16 v48, v219, v11, v48
  v_dot2_f32_bf16 v49, v220, v8, 0
  v_dot2_f32_bf16 v49, v221, v9, v49
  v_dot2_f32_bf16 v49, v222, v10, v49
  v_dot2_f32_bf16 v49, v223, v11, v49
  s_cbranch_vccnz L_h91
  s_waitcnt vmcnt(4)
L_h91:
  s_waitcnt vmcnt(7)
  buffer_load_dwordx4 v[140:143], v2, s[32:35], s80 offen nt
  s_add_u32 s80, s80, 4096
  s_and_b32 s80, s80, 0x7ffff
  v_dot2_f32_bf16 v50, v224, v8, 0
  v_dot2_f32_bf16 v50, v225, v9, v50
  v_dot2_f32_bf16 v50, v226, v10, v50
  v_dot2_f32_bf16 v50, v227, v11, v50
  v_dot2_f32_bf16 v51, v228, v8, 0
  v_dot2_f32_bf16 v51, v229, v9, v51
  v_dot2_f32_bf16 v51, v230, v10, v51
  v_dot2_f32_bf16 v51, v231, v11, v51
  v_dot2_f32_bf16 v52, v232, v8, 0
  v_dot2_f32_bf16 v52, v233, v9, v52
  v_dot2_f32_bf16 v52, v234, v10, v52
  v_dot2_f32_bf16 v52, v235, v11, v52
  v_dot2_f32_bf16 v53, v236, v8, 0
  v_dot2_f32_bf16 v53, v237, v9, v53
  v_dot2_f32_bf16 v53, v238, v10, v53
  v_dot2_f32_bf16 v53, v239, v11, v53
  v_dot2_f32_bf16 v54, v240, v8, 0
  v_dot2_f32_bf16 v54, v241, v9, v54
  v_dot2_f32_bf16 v54, v242, v10, v54
  v_dot2_f32_bf16 v54, v243, v11, v54
  v_dot2_f32_bf16 v55, v244, v8, 0
  v_dot2_f32_bf16 v55, v245, v9, v55
  v_dot2_f32_bf16 v55, v246, v10, v55
  v_dot2_f32_bf16 v55, v247, v11, v55
  s_cbranch_vccnz L_h92
  s_waitcnt vmcnt(4)
L_h92:
  s_waitcnt vmcnt(7)
  buffer_load_dwordx4 v[144:147], v2, s[32:35], s80 offen nt
  s_add_u32 s80, s80, 4096
  s_and_b32 s80, s80, 0x7ffff
  v_dot2_f32_bf16 v56, v248, v8, 0
  v_dot2_f32_bf16 v56, v249, v9, v56
  v_dot2_f32_bf16 v56, v250, v10, v56
  v_dot2_f32_bf16 v56, v251, v11, v56
  v_dot2_f32_bf16 v57, v252, v8, 0
  v_dot2_f32_bf16 v57, v253, v9, v57
  v_dot2_f32_bf16 v57, v254, v10, v57
  v_dot2_f32_bf16 v57, v255, v11, v57
  v_dot2_f32_bf16 v58, v72, v8, 0
  v_dot2_f32_bf16 v58, v73, v9, v58
  v_dot2_f32_bf16 v58, v74, v10, v58
  v_dot2_f32_bf16 v58, v75, v11, v58
  v_dot2_f32_bf16 v59, v76, v8, 0
  v_dot2_f32_bf16 v59, v77, v9, v59
  v_dot2_f32_bf16 v59, v78, v10, v59
  v_dot2_f32_bf16 v59, v79, v11, v59
  v_dot2_f32_bf16 v60, v80, v8, 0
  v_dot2_f32_bf16 v60, v81, v9, v60
  v_dot2_f32_bf16 v60, v82, v10, v60
  v_dot2_f32_bf16 v60, v83, v11, v60
  v_dot2_f32_bf16 v61, v84, v8, 0
  v_dot2_f32_bf16 v61, v85, v9, v61
  v_dot2_f32_bf16 v61, v86, v10, v61
  v_dot2_f32_bf16 v61, v87, v11, v61
  s_cbranch_vccnz L_h93
  s_waitcnt vmcnt(4)
L_h93:
  s_waitcnt vmcnt(7)
  buffer_load_dwordx4 v[148:151], v2, s[32:35], s80 offen nt
  s_add_u32 s80, s80, 4096
  s_and_b32 s80, s80, 0x7ffff
  ds_read_b128 v[152:155], v40 offset:0
  v_dot2_f32_bf16 v62, v88, v8, 0
  v_dot2_f32_bf16 v62, v89, v9, v62
  v_dot2_f32_bf16 v62, v90, v10, v62
  v_dot2_f32_bf16 v62, v91, v11, v62
  ds_read_b128 v[156:159], v40 offset:1024
  v_dot2_f32_bf16 v63, v92, v8, 0
  v_dot2_f32_bf16 v63, v93, v9, v63
  v_dot2_f32_bf16 v63, v94, v10, v63
  v_dot2_f32_bf16 v63, v95, v11, v63
  v_add_f32_dpp v48, v48, v48 row_mirror row_mask:0xf bank_mask:0x3
  s_nop 1
  v_add_f32_dpp v48, v56, v56 row_mirror row_mask:0xf bank_mask:0xc
  v_add_f32_dpp v49, v49, v49 row_mirror row_mask:0xf bank_mask:0x3
  s_nop 1
  v_add_f32_dpp v49, v57, v57 row_mirror row_mask:0xf bank_mask:0xc
  v_add_f32_dpp v50, v50, v50 row_mirror row_mask:0xf bank_mask:0x3
  s_nop 1
  v_add_f32_dpp v50, v58, v58 row_mirror row_mask:0xf bank_mask:0xc
  v_add_f32_dpp v51, v51, v51 row_mirror row_mask:0xf bank_mask:0x3
  s_nop 1
  v_add_f32_dpp v51, v59, v59 row_mirror row_mask:0xf bank_mask:0xc
  v_add_f32_dpp v52, v52, v52 row_mirror row_mask:0xf bank_mask:0x3
  s_nop 1
  v_add_f32_dpp v52, v60, v60 row_mirror row_mask:0xf bank_mask:0xc
  v_add_f32_dpp v53, v53, v53 row_mirror row_mask:0xf bank_mask:0x3
  s_nop 1
  v_add_f32_dpp v53, v61, v61 row_mirror row_mask:0xf bank_mask:0xc
  v_add_f32_dpp v54, v54, v54 row_mirror row_mask:0xf bank_mask:0x3
  s_nop 1
  v_add_f32_dpp v54, v62, v62 row_mirror row_mask:0xf bank_mask:0xc
  v_add_f32_dpp v55, v55, v55 row_mirror row_mask:0xf bank_mask:0x3
  s_nop 1
  v_add_f32_dpp v55, v63, v63 row_mirror row_mask:0xf bank_mask:0xc
  v_add_f32_dpp v48, v48, v48 row_half_mirror row_mask:0xf bank_mask:0x5
  s_nop 1
  v_add_f32_dpp v48, v52, v52 row_half_mirror row_mask:0xf bank_mask:0xa
  v_add_f32_dpp v49, v49, v49 row_half_mirror row_mask:0xf bank_mask:0x5
  s_nop 1
  v_add_f32_dpp v49, v53, v53 row_half_mirror row_mask:0xf bank_mask:0xa
  v_add_f32_dpp v50, v50, v50 row_half_mirror row_mask:0xf bank_mask:0x5
  s_nop 1
  v_add_f32_dpp v50, v54, v54 row_half_mirror row_mask:0xf bank_mask:0xa
  v_add_f32_dpp v51, v51, v51 row_half_mirror row_mask:0xf bank_mask:0x5
  s_nop 1
  v_add_f32_dpp v51, v55, v55 row_half_mirror row_mask:0xf bank_mask:0xa
  v_add_f32_dpp v48, v48, v48 quad_perm:[2,3,0,1] row_mask:0xf bank_mask:0xf
  v_add_f32_dpp v49, v49, v49 quad_perm:[2,3,0,1] row_mask:0xf bank_mask:0xf
  v_add_f32_dpp v50, v50, v50 quad_perm:[2,3,0,1] row_mask:0xf bank_mask:0xf
  v_add_f32_dpp v51, v51, v51 quad_perm:[2,3,0,1] row_mask:0xf bank_mask:0xf
  v_add_f32_dpp v72, v48, v48 quad_perm:[1,0,3,2] row_mask:0xf bank_mask:0xf
  v_add_f32_dpp v73, v49, v49 quad_perm:[1,0,3,2] row_mask:0xf bank_mask:0xf
  v_add_f32_dpp v74, v50, v50 quad_perm:[1,0,3,2] row_mask:0xf bank_mask:0xf
  v_add_f32_dpp v75, v51, v51 quad_perm:[1,0,3,2] row_mask:0xf bank_mask:0xf
  v_cvt_pk_bf16_f32 v73, v72, v73
  v_cvt_pk_bf16_f32 v75, v74, v75
  v_lshlrev_b32 v72, 16, v73
  v_lshlrev_b32 v74, 16, v75
  v_and_b32 v73, 0xffff0000, v73
  v_and_b32 v75, 0xffff0000, v75
  v_mul_f32 v72, 0x3db504f3, v72
  v_mul_f32 v73, 0x3db504f3, v73
  v_mul_f32 v74, 0x3db504f3, v74
  v_mul_f32 v75, 0x3db504f3, v75
  v_cvt_pk_bf16_f32 v73, v72, v73
  v_cvt_pk_bf16_f32 v75, v74, v75
  v_lshlrev_b32 v72, 16, v73
  v_lshlrev_b32 v74, 16, v75
  v_and_b32 v73, 0xffff0000, v73
  v_and_b32 v75, 0xffff0000, v75
  v_max3_f32 v41, v41, v72, v73
  v_max3_f32 v41, v41, v74, v75
  ds_read_b128 v[160:163], v40 offset:2048
  s_waitcnt lgkmcnt(2)
  v_dot2_f32_bf16 v48, v152, v8, 0
  v_dot2_f32_bf16 v48, v153, v9, v48
  v_dot2_f32_bf16 v48, v154, v10, v48
  v_dot2_f32_bf16 v48, v155, v11, v48
  ds_read_b128 v[164:167], v40 offset:3072
  s_waitcnt lgkmcnt(2)
  v_dot2_f32_bf16 v49, v156, v8, 0
  v_dot2_f32_bf16 v49, v157, v9, v49
  v_dot2_f32_bf16 v49, v158, v10, v49
  v_dot2_f32_bf16 v49, v159, v11, v49
  ds_read_b128 v[168:171], v40 offset:4096
  s_waitcnt lgkmcnt(2)
  v_dot2_f32_bf16 v50, v160, v8, 0
  v_dot2_f32_bf16 v50, v161, v9, v50
  v_dot2_f32_bf16 v50, v162, v10, v50
  v_dot2_f32_bf16 v50, v163, v11, v50
  ds_read_b128 v[172:175], v40 offset:5120
  s_waitcnt lgkmcnt(2)
  v_dot2_f32_bf16 v51, v164, v8, 0
  v_dot2_f32_bf16 v51, v165, v9, v51
  v_dot2_f32_bf16 v51, v166, v10, v51
  v_dot2_f32_bf16 v51, v167, v11, v51
  s_cbranch_vccnz L_h94
  s_waitcnt vmcnt(4)
L_h94:
  s_waitcnt vmcnt(7)
  buffer_load_dwordx4 v[176:179], v2, s[32:35], s80 offen nt
  s_add_u32 s80, s80, 4096
  s_and_b32 s80, s80, 0x7ffff
  ds_read_b128 v[180:183], v40 offset:6144
  s_waitcnt lgkmcnt(2)
  v_dot2_f32_bf16 v52, v168, v8, 0
  v_dot2_f32_bf16 v52, v169, v9, v52
  v_dot2_f32_bf16 v52, v170, v10, v52
  v_dot2_f32_bf16 v52, v171, v11, v52
  ds_read_b128 v[184:187], v40 offset:7168
  s_waitcnt lgkmcnt(2)
  v_dot2_f32_bf16 v53, v172, v8, 0
  v_dot2_f32_bf16 v53, v173, v9, v53
  v_dot2_f32_bf16 v53, v174, v10, v53
  v_dot2_f32_bf16 v53, v175, v11, v53
  ds_read_b128 v[188:191], v40 offset:8192
  s_waitcnt lgkmcnt(2)
  v_dot2_f32_bf16 v54, v180, v8, 0
  v_dot2_f32_bf16 v54, v181, v9, v54
  v_dot2_f32_bf16 v54, v182, v10, v54
  v_dot2_f32_bf16 v54, v183, v11, v54
  ds_read_b128 v[192:195], v40 offset:9216
  s_waitcnt lgkmcnt(2)
  v_dot2_f32_bf16 v55, v184, v8, 0
  v_dot2_f32_bf16 v55, v185, v9, v55
  v_dot2_f32_bf16 v55, v186, v10, v55
  v_dot2_f32_bf16 v55, v187, v11, v55
  ds_read_b128 v[196:199], v40 offset:10240
  s_waitcnt lgkmcnt(2)
  v_dot2_f32_bf16 v56, v188, v8, 0
  v_dot2_f32_bf16 v56, v189, v9, v56
  v_dot2_f32_bf16 v56, v190, v10, v56
  v_dot2_f32_bf16 v56, v191, v11, v56
  ds_read_b128 v[200:203], v40 offset:11264
  s_waitcnt lgkmcnt(2)
  v_dot2_f32_bf16 v57, v192, v8, 0
  v_dot2_f32_bf16 v57, v193, v9, v57
  v_dot2_f32_bf16 v57, v194, v10, v57
  v_dot2_f32_bf16 v57, v195, v11, v57
  s_cbranch_vccnz L_h95
  s_waitcnt vmcnt(4)
L_h95:
  s_waitcnt vmcnt(7)
  buffer_load_dwordx4 v[204:207], v2, s[32:35], s80 offen nt
  s_add_u32 s80, s80, 4096
  s_and_b32 s80, s80, 0x7ffff
  ds_read_b128 v[208:211], v40 offset:12288
  s_waitcnt lgkmcnt(2)
  v_dot2_f32_bf16 v58, v196, v8, 0
  v_dot2_f32_bf16 v58, v197, v9, v58
  v_dot2_f32_bf16 v58, v198, v10, v58
  v_dot2_f32_bf16 v58, v199, v11, v58
  ds_read_b128 v[212:215], v40 offset:13312
  s_waitcnt lgkmcnt(2)
  v_dot2_f32_bf16 v59, v200, v8, 0
  v_dot2_f32_bf16 v59, v201, v9, v59
  v_dot2_f32_bf16 v59, v202, v10, v59
  v_dot2_f32_bf16 v59, v203, v11, v59
  ds_read_b128 v[216:219], v40 offset:14336
  s_waitcnt lgkmcnt(2)
  v_dot2_f32_bf16 v60, v208, v8, 0
  v_dot2_f32_bf16 v60, v209, v9, v60
  v_dot2_f32_bf16 v60, v210, v10, v60
  v_dot2_f32_bf16 v60, v211, v11, v60
  ds_read_b128 v[220:223], v40 offset:15360
  s_waitcnt lgkmcnt(2)
  v_dot2_f32_bf16 v61, v212, v8, 0
  v_dot2_f32_bf16 v61, v213, v9, v61
  v_dot2_f32_bf16 v61, v214, v10, v61
  v_dot2_f32_bf16 v61, v215, v11, v61
  ds_read_b128 v[224:227], v40 offset:16384
  s_waitcnt lgkmcnt(2)
  v_dot2_f32_bf16 v62, v216, v8, 0
  v_dot2_f32_bf16 v62, v217, v9, v62
  v_dot2_f32_bf16 v62, v218, v10, v62
  v_dot2_f32_bf16 v62, v219, v11, v62
  ds_read_b128 v[228:231], v40 offset:17408
  s_waitcnt lgkmcnt(2)
  v_dot2_f32_bf16 v63, v220, v8, 0
  v_dot2_f32_bf16 v63, v221, v9, v63
  v_dot2_f32_bf16 v63, v222, v10, v63
  v_dot2_f32_bf16 v63, v223, v11, v63
  s_cbranch_vccnz L_h96
  s_waitcnt vmcnt(4)
L_h96:
  s_waitcnt vmcnt(7)
  buffer_load_dwordx4 v[232:235], v2, s[32:35], s80 offen nt
  s_add_u32 s80, s80, 4096
  s_and_b32 s80, s80, 0x7ffff
  v_add_f32_dpp v48, v48, v48 row_mirror row_mask:0xf bank_mask:0x3
  s_nop 1
  v_add_f32_dpp v48, v56, v56 row_mirror row_mask:0xf bank_mask:0xc
  v_add_f32_dpp v49, v49, v49 row_mirror row_mask:0xf bank_mask:0x3
  s_nop 1
  v_add_f32_dpp v49, v57, v57 row_mirror row_mask:0xf bank_mask:0xc
  v_add_f32_dpp v50, v50, v50 row_mirror row_mask:0xf bank_mask:0x3
  s_nop 1
  v_add_f32_dpp v50, v58, v58 row_mirror row_mask:0xf bank_mask:0xc
  v_add_f32_dpp v51, v51, v51 row_mirror row_mask:0xf bank_mask:0x3
  s_nop 1
  v_add_f32_dpp v51, v59, v59 row_mirror row_mask:0xf bank_mask:0xc
  v_add_f32_dpp v52, v52, v52 row_mirror row_mask:0xf bank_mask:0x3
  s_nop 1
  v_add_f32_dpp v52, v60, v60 row_mirror row_mask:0xf bank_mask:0xc
  v_add_f32_dpp v53, v53, v53 row_mirror row_mask:0xf bank_mask:0x3
  s_nop 1
  v_add_f32_dpp v53, v61, v61 row_mirror row_mask:0xf bank_mask:0xc
  v_add_f32_dpp v54, v54, v54 row_mirror row_mask:0xf bank_mask:0x3
  s_nop 1
  v_add_f32_dpp v54, v62, v62 row_mirror row_mask:0xf bank_mask:0xc
  v_add_f32_dpp v55, v55, v55 row_mirror row_mask:0xf bank_mask:0x3
  s_nop 1
  v_add_f32_dpp v55, v63, v63 row_mirror row_mask:0xf bank_mask:0xc
  v_add_f32_dpp v48, v48, v48 row_half_mirror row_mask:0xf bank_mask:0x5
  s_nop 1
  v_add_f32_dpp v48, v52, v52 row_half_mirror row_mask:0xf bank_mask:0xa
  v_add_f32_dpp v49, v49, v49 row_half_mirror row_mask:0xf bank_mask:0x5
  s_nop 1
  v_add_f32_dpp v49, v53, v53 row_half_mirror row_mask:0xf bank_mask:0xa
  v_add_f32_dpp v50, v50, v50 row_half_mirror row_mask:0xf bank_mask:0x5
  s_nop 1
  v_add_f32_dpp v50, v54, v54 row_half_mirror row_mask:0xf bank_mask:0xa
  v_add_f32_dpp v51, v51, v51 row_half_mirror row_mask:0xf bank_mask:0x5
  s_nop 1
  v_add_f32_dpp v51, v55, v55 row_half_mirror row_mask:0xf bank_mask:0xa
  v_add_f32_dpp v48, v48, v48 quad_perm:[2,3,0,1] row_mask:0xf bank_mask:0xf
  v_add_f32_dpp v49, v49, v49 quad_perm:[2,3,0,1] row_mask:0xf bank_mask:0xf
  v_add_f32_dpp v50, v50, v50 quad_perm:[2,3,0,1] row_mask:0xf bank_mask:0xf
  v_add_f32_dpp v51, v51, v51 quad_perm:[2,3,0,1] row_mask:0xf bank_mask:0xf
  v_add_f32_dpp v76, v48, v48 quad_perm:[1,0,3,2] row_mask:0xf bank_mask:0xf
  v_add_f32_dpp v77, v49, v49 quad_perm:[1,0,3,2] row_mask:0xf bank_mask:0xf
  v_add_f32_dpp v78, v50, v50 quad_perm:[1,0,3,2] row_mask:0xf bank_mask:0xf
  v_add_f32_dpp v79, v51, v51 quad_perm:[1,0,3,2] row_mask:0xf bank_mask:0xf
  v_cvt_pk_bf16_f32 v77, v76, v77
  v_cvt_pk_bf16_f32 v79, v78, v79
  v_lshlrev_b32 v76, 16, v77
  v_lshlrev_b32 v78, 16, v79
  v_and_b32 v77, 0xffff0000, v77
  v_and_b32 v79, 0xffff0000, v79
  v_mul_f32 v76, 0x3db504f3, v76
  v_mul_f32 v77, 0x3db504f3, v77
  v_mul_f32 v78, 0x3db504f3, v78
  v_mul_f32 v79, 0x3db504f3, v79
  v_cvt_pk_bf16_f32 v77, v76, v77
  v_cvt_pk_bf16_f32 v79, v78, v79
  v_lshlrev_b32 v76, 16, v77
  v_lshlrev_b32 v78, 16, v79
  v_and_b32 v77, 0xffff0000, v77
  v_and_b32 v79, 0xffff0000, v79
  v_max3_f32 v41, v41, v76, v77
  v_max3_f32 v41, v41, v78, v79
  ds_read_b128 v[236:239], v40 offset:18432
  s_waitcnt lgkmcnt(2)
  v_dot2_f32_bf16 v48, v224, v8, 0
  v_dot2_f32_bf16 v48, v225, v9, v48
  v_dot2_f32_bf16 v48, v226, v10, v48
  v_dot2_f32_bf16 v48, v227, v11, v48
  ds_read_b128 v[240:243], v40 offset:19456
  s_waitcnt lgkmcnt(2)
  v_dot2_f32_bf16 v49, v228, v8, 0
  v_dot2_f32_bf16 v49, v229, v9, v49
  v_dot2_f32_bf16 v49, v230, v10, v49
  v_dot2_f32_bf16 v49, v231, v11, v49
  ds_read_b128 v[244:247], v40 offset:20480
  s_waitcnt lgkmcnt(2)
  v_dot2_f32_bf16 v50, v236, v8, 0
  v_dot2_f32_bf16 v50, v237, v9, v50
  v_dot2_f32_bf16 v50, v238, v10, v50
  v_dot2_f32_bf16 v50, v239, v11, v50
  ds_read_b128 v[248:251], v40 offset:21504
  s_waitcnt lgkmcnt(2)
  v_dot2_f32_bf16 v51, v240, v8, 0
  v_dot2_f32_bf16 v51, v241, v9, v51
  v_dot2_f32_bf16 v51, v242, v10, v51
  v_dot2_f32_bf16 v51, v243, v11, v51
  ds_read_b128 v[252:255], v40 offset:22528
  s_waitcnt lgkmcnt(2)
  v_dot2_f32_bf16 v52, v244, v8, 0
  v_dot2_f32_bf16 v52, v245, v9, v52
  v_dot2_f32_bf16 v52, v246, v10, v52
  v_dot2_f32_bf16 v52, v247, v11, v52
  ds_read_b128 v[152:155], v40 offset:23552
  s_waitcnt lgkmcnt(2)
  v_dot2_f32_bf16 v53, v248, v8, 0
  v_dot2_f32_bf16 v53, v249, v9, v53
  v_dot2_f32_bf16 v53, v250, v10, v53
  v_dot2_f32_bf16 v53, v251, v11, v53
  s_cbranch_vccnz L_h97
  s_waitcnt vmcnt(4)
L_h97:
  s_waitcnt vmcnt(7)
  buffer_load_dwordx4 v[156:159], v2, s[32:35], s80 offen nt
  s_add_u32 s80, s80, 4096
  s_and_b32 s80, s80, 0x7ffff
  ds_read_b128 v[160:163], v40 offset:24576
  s_waitcnt lgkmcnt(2)
  v_dot2_f32_bf16 v54, v252, v8, 0
  v_dot2_f32_bf16 v54, v253, v9, v54
  v_dot2_f32_bf16 v54, v254, v10, v54
  v_dot2_f32_bf16 v54, v255, v11, v54
  ds_read_b128 v[164:167], v40 offset:25600
  s_waitcnt lgkmcnt(2)
  v_dot2_f32_bf16 v55, v152, v8, 0
  v_dot2_f32_bf16 v55, v153, v9, v55
  v_dot2_f32_bf16 v55, v154, v10, v55
  v_dot2_f32_bf16 v55, v155, v11, v55
  ds_read_b128 v[168:171], v40 offset:26624
  s_waitcnt lgkmcnt(2)
  v_dot2_f32_bf16 v56, v160, v8, 0
  v_dot2_f32_bf16 v56, v161, v9, v56
  v_dot2_f32_bf16 v56, v162, v10, v56
  v_dot2_f32_bf16 v56, v163, v11, v56
  ds_read_b128 v[172:175], v40 offset:27648
  s_waitcnt lgkmcnt(2)
  v_dot2_f32_bf16 v57, v164, v8, 0
  v_dot2_f32_bf16 v57, v165, v9, v57
  v_dot2_f32_bf16 v57, v166, v10, v57
  v_dot2_f32_bf16 v57, v167, v11, v57
  ds_read_b128 v[180:183], v40 offset:28672
  s_waitcnt lgkmcnt(2)
  v_dot2_f32_bf16 v58, v168, v8, 0
  v_dot2_f32_bf16 v58, v169, v9, v58
  v_dot2_f32_bf16 v58, v170, v10, v58
  v_dot2_f32_bf16 v58, v171, v11, v58
  ds_read_b128 v[184:187], v40 offset:29696
  s_waitcnt lgkmcnt(2)
  v_dot2_f32_bf16 v59, v172, v8, 0
  v_dot2_f32_bf16 v59, v173, v9, v59
  v_dot2_f32_bf16 v59, v174, v10, v59
  v_dot2_f32_bf16 v59, v175, v11, v59
  s_cbranch_vccnz L_h98
  s_waitcnt vmcnt(4)
L_h98:
  s_waitcnt vmcnt(7)
  buffer_load_dwordx4 v[188:191], v2, s[32:35], s80 offen nt
  s_add_u32 s80, s80, 4096
  s_and_b32 s80, s80, 0x7ffff
  ds_read_b128 v[192:195], v40 offset:30720
  s_waitcnt lgkmcnt(2)
  v_dot2_f32_bf16 v60, v180, v8, 0
  v_dot2_f32_bf16 v60, v181, v9, v60
  v_dot2_f32_bf16 v60, v182, v10, v60
  v_dot2_f32_bf16 v60, v183, v11, v60
  ds_read_b128 v[196:199], v40 offset:31744
  s_waitcnt lgkmcnt(2)
  v_dot2_f32_bf16 v61, v184, v8, 0
  v_dot2_f32_bf16 v61, v185, v9, v61
  v_dot2_f32_bf16 v61, v186, v10, v61
  v_dot2_f32_bf16 v61, v187, v11, v61
  s_waitcnt lgkmcnt(1)
  v_dot2_f32_bf16 v62, v192, v8, 0
  v_dot2_f32_bf16 v62, v193, v9, v62
  v_dot2_f32_bf16 v62, v194, v10, v62
  v_dot2_f32_bf16 v62, v195, v11, v62
  s_waitcnt lgkmcnt(0)
  v_dot2_f32_bf16 v63, v196, v8, 0
  v_dot2_f32_bf16 v63, v197, v9, v63
  v_dot2_f32_bf16 v63, v198, v10, v63
  v_dot2_f32_bf16 v63, v199, v11, v63
  v_add_f32_dpp v48, v48, v48 row_mirror row_mask:0xf bank_mask:0x3
  s_nop 1
  v_add_f32_dpp v48, v56, v56 row_mirror row_mask:0xf bank_mask:0xc
  v_add_f32_dpp v49, v49, v49 row_mirror row_mask:0xf bank_mask:0x3
  s_nop 1
  v_add_f32_dpp v49, v57, v57 row_mirror row_mask:0xf bank_mask:0xc
  v_add_f32_dpp v50, v50, v50 row_mirror row_mask:0xf bank_mask:0x3
  s_nop 1
  v_add_f32_dpp v50, v58, v58 row_mirror row_mask:0xf bank_mask:0xc
  v_add_f32_dpp v51, v51, v51 row_mirror row_mask:0xf bank_mask:0x3
  s_nop 1
  v_add_f32_dpp v51, v59, v59 row_mirror row_mask:0xf bank_mask:0xc
  v_add_f32_dpp v52, v52, v52 row_mirror row_mask:0xf bank_mask:0x3
  s_nop 1
  v_add_f32_dpp v52, v60, v60 row_mirror row_mask:0xf bank_mask:0xc
  v_add_f32_dpp v53, v53, v53 row_mirror row_mask:0xf bank_mask:0x3
  s_nop 1
  v_add_f32_dpp v53, v61, v61 row_mirror row_mask:0xf bank_mask:0xc
  v_add_f32_dpp v54, v54, v54 row_mirror row_mask:0xf bank_mask:0x3
  s_nop 1
  v_add_f32_dpp v54, v62, v62 row_mirror row_mask:0xf bank_mask:0xc
  v_add_f32_dpp v55, v55, v55 row_mirror row_mask:0xf bank_mask:0x3
  s_nop 1
  v_add_f32_dpp v55, v63, v63 row_mirror row_mask:0xf bank_mask:0xc
  v_add_f32_dpp v48, v48, v48 row_half_mirror row_mask:0xf bank_mask:0x5
  s_nop 1
  v_add_f32_dpp v48, v52, v52 row_half_mirror row_mask:0xf bank_mask:0xa
  v_add_f32_dpp v49, v49, v49 row_half_mirror row_mask:0xf bank_mask:0x5
  s_nop 1
  v_add_f32_dpp v49, v53, v53 row_half_mirror row_mask:0xf bank_mask:0xa
  v_add_f32_dpp v50, v50, v50 row_half_mirror row_mask:0xf bank_mask:0x5
  s_nop 1
  v_add_f32_dpp v50, v54, v54 row_half_mirror row_mask:0xf bank_mask:0xa
  v_add_f32_dpp v51, v51, v51 row_half_mirror row_mask:0xf bank_mask:0x5
  s_nop 1
  v_add_f32_dpp v51, v55, v55 row_half_mirror row_mask:0xf bank_mask:0xa
  v_add_f32_dpp v48, v48, v48 quad_perm:[2,3,0,1] row_mask:0xf bank_mask:0xf
  v_add_f32_dpp v49, v49, v49 quad_perm:[2,3,0,1] row_mask:0xf bank_mask:0xf
  v_add_f32_dpp v50, v50, v50 quad_perm:[2,3,0,1] row_mask:0xf bank_mask:0xf
  v_add_f32_dpp v51, v51, v51 quad_perm:[2,3,0,1] row_mask:0xf bank_mask:0xf
  v_add_f32_dpp v80, v48, v48 quad_perm:[1,0,3,2] row_mask:0xf bank_mask:0xf
  v_add_f32_dpp v81, v49, v49 quad_perm:[1,0,3,2] row_mask:0xf bank_mask:0xf
  v_add_f32_dpp v82, v50, v50 quad_perm:[1,0,3,2] row_mask:0xf bank_mask:0xf
  v_add_f32_dpp v83, v51, v51 quad_perm:[1,0,3,2] row_mask:0xf bank_mask:0xf
  v_cvt_pk_bf16_f32 v81, v80, v81
  v_cvt_pk_bf16_f32 v83, v82, v83
  v_lshlrev_b32 v80, 16, v81
  v_lshlrev_b32 v82, 16, v83
  v_and_b32 v81, 0xffff0000, v81
  v_and_b32 v83, 0xffff0000, v83
  v_mul_f32 v80, 0x3db504f3, v80
  v_mul_f32 v81, 0x3db504f3, v81
  v_mul_f32 v82, 0x3db504f3, v82
  v_mul_f32 v83, 0x3db504f3, v83
  v_cvt_pk_bf16_f32 v81, v80, v81
  v_cvt_pk_bf16_f32 v83, v82, v83
  v_lshlrev_b32 v80, 16, v81
  v_lshlrev_b32 v82, 16, v83
  v_and_b32 v81, 0xffff0000, v81
  v_and_b32 v83, 0xffff0000, v83
  v_max3_f32 v41, v41, v80, v81
  v_max3_f32 v41, v41, v82, v83
  v_dot2_f32_bf16 v48, v96, v8, 0
  v_dot2_f32_bf16 v48, v97, v9, v48
  v_dot2_f32_bf16 v48, v98, v10, v48
  v_dot2_f32_bf16 v48, v99, v11, v48
  v_dot2_f32_bf16 v49, v100, v8, 0
  v_dot2_f32_bf16 v49, v101, v9, v49
  v_dot2_f32_bf16 v49, v102, v10, v49
  v_dot2_f32_bf16 v49, v103, v11, v49
  s_cbranch_vccnz L_h99
  s_waitcnt vmcnt(4)
L_h99:
  s_waitcnt vmcnt(7)
  buffer_load_dwordx4 v[200:203], v2, s[32:35], s80 offen nt
  s_add_u32 s80, s80, 4096
  s_and_b32 s80, s80, 0x7ffff
  v_dot2_f32_bf16 v50, v104, v8, 0
  v_dot2_f32_bf16 v50, v105, v9, v50
  v_dot2_f32_bf16 v50, v106, v10, v50
  v_dot2_f32_bf16 v50, v107, v11, v50
  v_dot2_f32_bf16 v51, v108, v8, 0
  v_dot2_f32_bf16 v51, v109, v9, v51
  v_dot2_f32_bf16 v51, v110, v10, v51
  v_dot2_f32_bf16 v51, v111, v11, v51
  v_dot2_f32_bf16 v52, v112, v8, 0
  v_dot2_f32_bf16 v52, v113, v9, v52
  v_dot2_f32_bf16 v52, v114, v10, v52
  v_dot2_f32_bf16 v52, v115, v11, v52
  v_dot2_f32_bf16 v53, v116, v8, 0
  v_dot2_f32_bf16 v53, v117, v9, v53
  v_dot2_f32_bf16 v53, v118, v10, v53
  v_dot2_f32_bf16 v53, v119, v11, v53
  v_dot2_f32_bf16 v54, v120, v8, 0
  v_dot2_f32_bf16 v54, v121, v9, v54
  v_dot2_f32_bf16 v54, v122, v10, v54
  v_dot2_f32_bf16 v54, v123, v11, v54
  v_dot2_f32_bf16 v55, v124, v8, 0
  v_dot2_f32_bf16 v55, v125, v9, v55
  v_dot2_f32_bf16 v55, v126, v10, v55
  v_dot2_f32_bf16 v55, v127, v11, v55
  s_cbranch_vccnz L_h100
  s_waitcnt vmcnt(4)
L_h100:
  s_waitcnt vmcnt(7)
  buffer_load_dwordx4 v[208:211], v2, s[32:35], s80 offen nt
  s_add_u32 s80, s80, 4096
  s_and_b32 s80, s80, 0x7ffff
  v_dot2_f32_bf16 v56, v128, v8, 0
  v_dot2_f32_bf16 v56, v129, v9, v56
  v_dot2_f32_bf16 v56, v130, v10, v56
  v_dot2_f32_bf16 v56, v131, v11, v56
  v_dot2_f32_bf16 v57, v132, v8, 0
  v_dot2_f32_bf16 v57, v133, v9, v57
  v_dot2_f32_bf16 v57, v134, v10, v57
  v_dot2_f32_bf16 v57, v135, v11, v57
  v_dot2_f32_bf16 v58, v136, v8, 0
  v_dot2_f32_bf16 v58, v137, v9, v58
  v_dot2_f32_bf16 v58, v138, v10, v58
  v_dot2_f32_bf16 v58, v139, v11, v58
  v_dot2_f32_bf16 v59, v140, v8, 0
  v_dot2_f32_bf16 v59, v141, v9, v59
  v_dot2_f32_bf16 v59, v142, v10, v59
  v_dot2_f32_bf16 v59, v143, v11, v59
  v_dot2_f32_bf16 v60, v144, v8, 0
  v_dot2_f32_bf16 v60, v145, v9, v60
  v_dot2_f32_bf16 v60, v146, v10, v60
  v_dot2_f32_bf16 v60, v147, v11, v60
  s_waitcnt vmcnt(7)
  v_dot2_f32_bf16 v61, v148, v8, 0
  v_dot2_f32_bf16 v61, v149, v9, v61
  v_dot2_f32_bf16 v61, v150, v10, v61
  v_dot2_f32_bf16 v61, v151, v11, v61
  s_cbranch_vccnz L_h101
  s_waitcnt vmcnt(4)
L_h101:
  buffer_load_dwordx4 v[212:215], v2, s[32:35], s80 offen nt
  s_add_u32 s80, s80, 4096
  s_and_b32 s80, s80, 0x7ffff
  s_waitcnt vmcnt(7)
  v_dot2_f32_bf16 v62, v176, v8, 0
  v_dot2_f32_bf16 v62, v177, v9, v62
  v_dot2_f32_bf16 v62, v178, v10, v62
  v_dot2_f32_bf16 v62, v179, v11, v62
  s_cbranch_vccnz L_h102
  s_waitcnt vmcnt(4)
L_h102:
  buffer_load_dwordx4 v[216:219], v2, s[32:35], s80 offen nt
  s_add_u32 s80, s80, 4096
  s_and_b32 s80, s80, 0x7ffff
  s_waitcnt vmcnt(7)
  v_dot2_f32_bf16 v63, v204, v8, 0
  v_dot2_f32_bf16 v63, v205, v9, v63
  v_dot2_f32_bf16 v63, v206, v10, v63
  v_dot2_f32_bf16 v63, v207, v11, v63
  s_cbranch_vccnz L_h103
  s_waitcnt vmcnt(4)
L_h103:
  buffer_load_dwordx4 v[220:223], v2, s[32:35], s80 offen nt
  s_add_u32 s80, s80, 4096
  s_and_b32 s80, s80, 0x7ffff
  v_add_f32_dpp v48, v48, v48 row_mirror row_mask:0xf bank_mask:0x3
  s_nop 1
  v_add_f32_dpp v48, v56, v56 row_mirror row_mask:0xf bank_mask:0xc
  v_add_f32_dpp v49, v49, v49 row_mirror row_mask:0xf bank_mask:0x3
  s_nop 1
  v_add_f32_dpp v49, v57, v57 row_mirror row_mask:0xf bank_mask:0xc
  v_add_f32_dpp v50, v50, v50 row_mirror row_mask:0xf bank_mask:0x3
  s_nop 1
  v_add_f32_dpp v50, v58, v58 row_mirror row_mask:0xf bank_mask:0xc
  v_add_f32_dpp v51, v51, v51 row_mirror row_mask:0xf bank_mask:0x3
  s_nop 1
  v_add_f32_dpp v51, v59, v59 row_mirror row_mask:0xf bank_mask:0xc
  v_add_f32_dpp v52, v52, v52 row_mirror row_mask:0xf bank_mask:0x3
  s_nop 1
  v_add_f32_dpp v52, v60, v60 row_mirror row_mask:0xf bank_mask:0xc
  v_add_f32_dpp v53, v53, v53 row_mirror row_mask:0xf bank_mask:0x3
  s_nop 1
  v_add_f32_dpp v53, v61, v61 row_mirror row_mask:0xf bank_mask:0xc
  v_add_f32_dpp v54, v54, v54 row_mirror row_mask:0xf bank_mask:0x3
  s_nop 1
  v_add_f32_dpp v54, v62, v62 row_mirror row_mask:0xf bank_mask:0xc
  v_add_f32_dpp v55, v55, v55 row_mirror row_mask:0xf bank_mask:0x3
  s_nop 1
  v_add_f32_dpp v55, v63, v63 row_mirror row_mask:0xf bank_mask:0xc
  v_add_f32_dpp v48, v48, v48 row_half_mirror row_mask:0xf bank_mask:0x5
  s_nop 1
  v_add_f32_dpp v48, v52, v52 row_half_mirror row_mask:0xf bank_mask:0xa
  v_add_f32_dpp v49, v49, v49 row_half_mirror row_mask:0xf bank_mask:0x5
  s_nop 1
  v_add_f32_dpp v49, v53, v53 row_half_mirror row_mask:0xf bank_mask:0xa
  v_add_f32_dpp v50, v50, v50 row_half_mirror row_mask:0xf bank_mask:0x5
  s_nop 1
  v_add_f32_dpp v50, v54, v54 row_half_mirror row_mask:0xf bank_mask:0xa
  v_add_f32_dpp v51, v51, v51 row_half_mirror row_mask:0xf bank_mask:0x5
  s_nop 1
  v_add_f32_dpp v51, v55, v55 row_half_mirror row_mask:0xf bank_mask:0xa
  v_add_f32_dpp v48, v48, v48 quad_perm:[2,3,0,1] row_mask:0xf bank_mask:0xf
  v_add_f32_dpp v49, v49, v49 quad_perm:[2,3,0,1] row_mask:0xf bank_mask:0xf
  v_add_f32_dpp v50, v50, v50 quad_perm:[2,3,0,1] row_mask:0xf bank_mask:0xf
  v_add_f32_dpp v51, v51, v51 quad_perm:[2,3,0,1] row_mask:0xf bank_mask:0xf
  v_add_f32_dpp v84, v48, v48 quad_perm:[1,0,3,2] row_mask:0xf bank_mask:0xf
  v_add_f32_dpp v85, v49, v49 quad_perm:[1,0,3,2] row_mask:0xf bank_mask:0xf
  v_add_f32_dpp v86, v50, v50 quad_perm:[1,0,3,2] row_mask:0xf bank_mask:0xf
  v_add_f32_dpp v87, v51, v51 quad_perm:[1,0,3,2] row_mask:0xf bank_mask:0xf
  v_cvt_pk_bf16_f32 v85, v84, v85
  v_cvt_pk_bf16_f32 v87, v86, v87
  v_lshlrev_b32 v84, 16, v85
  v_lshlrev_b32 v86, 16, v87
  v_and_b32 v85, 0xffff0000, v85
  v_and_b32 v87, 0xffff0000, v87
  v_mul_f32 v84, 0x3db504f3, v84
  v_mul_f32 v85, 0x3db504f3, v85
  v_mul_f32 v86, 0x3db504f3, v86
  v_mul_f32 v87, 0x3db504f3, v87
  v_cvt_pk_bf16_f32 v85, v84, v85
  v_cvt_pk_bf16_f32 v87, v86, v87
  v_lshlrev_b32 v84, 16, v85
  v_lshlrev_b32 v86, 16, v87
  v_and_b32 v85, 0xffff0000, v85
  v_and_b32 v87, 0xffff0000, v87
  v_max3_f32 v41, v41, v84, v85
  v_max3_f32 v41, v41, v86, v87
  s_waitcnt vmcnt(7)
  v_dot2_f32_bf16 v48, v232, v8, 0
  v_dot2_f32_bf16 v48, v233, v9, v48
  v_dot2_f32_bf16 v48, v234, v10, v48
  v_dot2_f32_bf16 v48, v235, v11, v48
  s_cbranch_vccnz L_h104
  s_waitcnt vmcnt(4)
L_h104:
  buffer_load_dwordx4 v[224:227], v2, s[32:35], s80 offen nt
  s_add_u32 s80, s80, 4096
  s_and_b32 s80, s80, 0x7ffff
  s_waitcnt vmcnt(7)
  v_dot2_f32_bf16 v49, v156, v8, 0
  v_dot2_f32_bf16 v49, v157, v9, v49
  v_dot2_f32_bf16 v49, v158, v10, v49
  v_dot2_f32_bf16 v49, v159, v11, v49
  s_cbranch_vccnz L_h105
  s_waitcnt vmcnt(4)
L_h105:
  buffer_load_dwordx4 v[228:231], v2, s[32:35], s80 offen nt
  s_add_u32 s80, s80, 4096
  s_and_b32 s80, s80, 0x7ffff
  s_waitcnt vmcnt(7)
  v_dot2_f32_bf16 v50, v188, v8, 0
  v_dot2_f32_bf16 v50, v189, v9, v50
  v_dot2_f32_bf16 v50, v190, v10, v50
  v_dot2_f32_bf16 v50, v191, v11, v50
  s_cbranch_vccnz L_h106
  s_waitcnt vmcnt(4)
L_h106:
  buffer_load_dwordx4 v[236:239], v2, s[32:35], s80 offen nt
  s_add_u32 s80, s80, 4096
  s_and_b32 s80, s80, 0x7ffff
  s_waitcnt vmcnt(7)
  v_dot2_f32_bf16 v51, v200, v8, 0
  v_dot2_f32_bf16 v51, v201, v9, v51
  v_dot2_f32_bf16 v51, v202, v10, v51
  v_dot2_f32_bf16 v51, v203, v11, v51
  s_cbranch_vccnz L_h107
  s_waitcnt vmcnt(4)
L_h107:
  buffer_load_dwordx4 v[240:243], v2, s[32:35], s80 offen nt
  s_add_u32 s80, s80, 4096
  s_and_b32 s80, s80, 0x7ffff
  s_waitcnt vmcnt(7)
  v_dot2_f32_bf16 v52, v208, v8, 0
  v_dot2_f32_bf16 v52, v209, v9, v52
  v_dot2_f32_bf16 v52, v210, v10, v52
  v_dot2_f32_bf16 v52, v211, v11, v52
  s_cbranch_vccnz L_h108
  s_waitcnt vmcnt(4)
L_h108:
  buffer_load_dwordx4 v[244:247], v2, s[32:35], s80 offen nt
  s_add_u32 s80, s80, 4096
  s_and_b32 s80, s80, 0x7ffff
  s_waitcnt vmcnt(7)
  v_dot2_f32_bf16 v53, v212, v8, 0
  v_dot2_f32_bf16 v53, v213, v9, v53
  v_dot2_f32_bf16 v53, v214, v10, v53
  v_dot2_f32_bf16 v53, v215, v11, v53
  s_cbranch_vccnz L_h109
  s_waitcnt vmcnt(4)
L_h109:
  buffer_load_dwordx4 v[248:251], v2, s[32:35], s80 offen nt
  s_add_u32 s80, s80, 4096
  s_and_b32 s80, s80, 0x7ffff
  s_waitcnt vmcnt(7)
  v_dot2_f32_bf16 v54, v216, v8, 0
  v_dot2_f32_bf16 v54, v217, v9, v54
  v_dot2_f32_bf16 v54, v218, v10, v54
  v_dot2_f32_bf16 v54, v219, v11, v54
  s_cbranch_vccnz L_h110
  s_waitcnt vmcnt(4)
L_h110:
  buffer_load_dwordx4 v[252:255], v2, s[32:35], s80 offen nt
  s_add_u32 s80, s80, 4096
  s_and_b32 s80, s80, 0x7ffff
  s_waitcnt vmcnt(7)
  v_dot2_f32_bf16 v55, v220, v8, 0
  v_dot2_f32_bf16 v55, v221, v9, v55
  v_dot2_f32_bf16 v55, v222, v10, v55
  v_dot2_f32_bf16 v55, v223, v11, v55
  s_cbranch_vccnz L_h111
  s_waitcnt vmcnt(4)
L_h111:
  buffer_load_dwordx4 v[152:155], v2, s[32:35], s80 offen nt
  s_add_u32 s80, s80, 4096
  s_and_b32 s80, s80, 0x7ffff
  s_waitcnt vmcnt(7)
  v_dot2_f32_bf16 v56, v224, v8, 0
  v_dot2_f32_bf16 v56, v225, v9, v56
  v_dot2_f32_bf16 v56, v226, v10, v56
  v_dot2_f32_bf16 v56, v227, v11, v56
  s_cbranch_vccnz L_h112
  s_waitcnt vmcnt(4)
L_h112:
  buffer_load_dwordx4 v[160:163], v2, s[32:35], s80 offen nt
  s_add_u32 s80, s80, 4096
  s_and_b32 s80, s80, 0x7ffff
  s_waitcnt vmcnt(7)
  v_dot2_f32_bf16 v57, v228, v8, 0
  v_dot2_f32_bf16 v57, v229, v9, v57
  v_dot2_f32_bf16 v57, v230, v10, v57
  v_dot2_f32_bf16 v57, v231, v11, v57
  s_cbranch_vccnz L_h113
  s_waitcnt vmcnt(4)
L_h113:
  buffer_load_dwordx4 v[164:167], v2, s[32:35], s80 offen nt
  s_add_u32 s80, s80, 4096
  s_and_b32 s80, s80, 0x7ffff
  s_waitcnt vmcnt(7)
  v_dot2_f32_bf16 v58, v236, v8, 0
  v_dot2_f32_bf16 v58, v237, v9, v58
  v_dot2_f32_bf16 v58, v238, v10, v58
  v_dot2_f32_bf16 v58, v239, v11, v58
  s_cbranch_vccnz L_h114
  s_waitcnt vmcnt(4)
L_h114:
  buffer_load_dwordx4 v[168:171], v2, s[32:35], s80 offen nt
  s_add_u32 s80, s80, 4096
  s_and_b32 s80, s80, 0x7ffff
  s_waitcnt vmcnt(7)
  v_dot2_f32_bf16 v59, v240, v8, 0
  v_dot2_f32_bf16 v59, v241, v9, v59
  v_dot2_f32_bf16 v59, v242, v10, v59
  v_dot2_f32_bf16 v59, v243, v11, v59
  s_cbranch_vccnz L_h115
  s_waitcnt vmcnt(4)
L_h115:
  buffer_load_dwordx4 v[172:175], v2, s[32:35], s80 offen nt
  s_add_u32 s80, s80, 4096
  s_and_b32 s80, s80, 0x7ffff
  s_waitcnt vmcnt(7)
  v_dot2_f32_bf16 v60, v244, v8, 0
  v_dot2_f32_bf16 v60, v245, v9, v60
  v_dot2_f32_bf16 v60, v246, v10, v60
  v_dot2_f32_bf16 v60, v247, v11, v60
  s_cbranch_vccnz L_h116
  s_waitcnt vmcnt(4)
L_h116:
  buffer_load_dwordx4 v[180:183], v2, s[32:35], s80 offen nt
  s_add_u32 s80, s80, 4096
  s_and_b32 s80, s80, 0x7ffff
  s_waitcnt vmcnt(7)
  v_dot2_f32_bf16 v61, v248, v8, 0
  v_dot2_f32_bf16 v61, v249, v9, v61
  v_dot2_f32_bf16 v61, v250, v10, v61
  v_dot2_f32_bf16 v61, v251, v11, v61
  s_cbranch_vccnz L_h117
  s_waitcnt vmcnt(4)
L_h117:
  buffer_load_dwordx4 v[184:187], v2, s[32:35], s80 offen nt
  s_add_u32 s80, s80, 4096
  s_and_b32 s80, s80, 0x7ffff
  s_waitcnt vmcnt(7)
  v_dot2_f32_bf16 v62, v252, v8, 0
  v_dot2_f32_bf16 v62, v253, v9, v62
  v_dot2_f32_bf16 v62, v254, v10, v62
  v_dot2_f32_bf16 v62, v255, v11, v62
  s_cbranch_vccnz L_h118
  s_waitcnt vmcnt(4)
L_h118:
  buffer_load_dwordx4 v[192:195], v2, s[32:35], s80 offen nt
  s_add_u32 s80, s80, 4096
  s_and_b32 s80, s80, 0x7ffff
  s_waitcnt vmcnt(7)
  v_dot2_f32_bf16 v63, v152, v8, 0
  v_dot2_f32_bf16 v63, v153, v9, v63
  v_dot2_f32_bf16 v63, v154, v10, v63
  v_dot2_f32_bf16 v63, v155, v11, v63
  s_cbranch_vccnz L_h119
  s_waitcnt vmcnt(4)
L_h119:
  buffer_load_dwordx4 v[196:199], v2, s[32:35], s80 offen nt
  s_add_u32 s80, s80, 4096
  s_and_b32 s80, s80, 0x7ffff
  v_add_f32_dpp v48, v48, v48 row_mirror row_mask:0xf bank_mask:0x3
  s_nop 1
  v_add_f32_dpp v48, v56, v56 row_mirror row_mask:0xf bank_mask:0xc
  v_add_f32_dpp v49, v49, v49 row_mirror row_mask:0xf bank_mask:0x3
  s_nop 1
  v_add_f32_dpp v49, v57, v57 row_mirror row_mask:0xf bank_mask:0xc
  v_add_f32_dpp v50, v50, v50 row_mirror row_mask:0xf bank_mask:0x3
  s_nop 1
  v_add_f32_dpp v50, v58, v58 row_mirror row_mask:0xf bank_mask:0xc
  v_add_f32_dpp v51, v51, v51 row_mirror row_mask:0xf bank_mask:0x3
  s_nop 1
  v_add_f32_dpp v51, v59, v59 row_mirror row_mask:0xf bank_mask:0xc
  v_add_f32_dpp v52, v52, v52 row_mirror row_mask:0xf bank_mask:0x3
  s_nop 1
  v_add_f32_dpp v52, v60, v60 row_mirror row_mask:0xf bank_mask:0xc
  v_add_f32_dpp v53, v53, v53 row_mirror row_mask:0xf bank_mask:0x3
  s_nop 1
  v_add_f32_dpp v53, v61, v61 row_mirror row_mask:0xf bank_mask:0xc
  v_add_f32_dpp v54, v54, v54 row_mirror row_mask:0xf bank_mask:0x3
  s_nop 1
  v_add_f32_dpp v54, v62, v62 row_mirror row_mask:0xf bank_mask:0xc
  v_add_f32_dpp v55, v55, v55 row_mirror row_mask:0xf bank_mask:0x3
  s_nop 1
  v_add_f32_dpp v55, v63, v63 row_mirror row_mask:0xf bank_mask:0xc
  v_add_f32_dpp v48, v48, v48 row_half_mirror row_mask:0xf bank_mask:0x5
  s_nop 1
  v_add_f32_dpp v48, v52, v52 row_half_mirror row_mask:0xf bank_mask:0xa
  v_add_f32_dpp v49, v49, v49 row_half_mirror row_mask:0xf bank_mask:0x5
  s_nop 1
  v_add_f32_dpp v49, v53, v53 row_half_mirror row_mask:0xf bank_mask:0xa
  v_add_f32_dpp v50, v50, v50 row_half_mirror row_mask:0xf bank_mask:0x5
  s_nop 1
  v_add_f32_dpp v50, v54, v54 row_half_mirror row_mask:0xf bank_mask:0xa
  v_add_f32_dpp v51, v51, v51 row_half_mirror row_mask:0xf bank_mask:0x5
  s_nop 1
  v_add_f32_dpp v51, v55, v55 row_half_mirror row_mask:0xf bank_mask:0xa
  v_add_f32_dpp v48, v48, v48 quad_perm:[2,3,0,1] row_mask:0xf bank_mask:0xf
  v_add_f32_dpp v49, v49, v49 quad_perm:[2,3,0,1] row_mask:0xf bank_mask:0xf
  v_add_f32_dpp v50, v50, v50 quad_perm:[2,3,0,1] row_mask:0xf bank_mask:0xf
  v_add_f32_dpp v51, v51, v51 quad_perm:[2,3,0,1] row_mask:0xf bank_mask:0xf
  v_add_f32_dpp v88, v48, v48 quad_perm:[1,0,3,2] row_mask:0xf bank_mask:0xf
  v_add_f32_dpp v89, v49, v49 quad_perm:[1,0,3,2] row_mask:0xf bank_mask:0xf
  v_add_f32_dpp v90, v50, v50 quad_perm:[1,0,3,2] row_mask:0xf bank_mask:0xf
  v_add_f32_dpp v91, v51, v51 quad_perm:[1,0,3,2] row_mask:0xf bank_mask:0xf
  v_cvt_pk_bf16_f32 v89, v88, v89
  v_cvt_pk_bf16_f32 v91, v90, v91
  v_lshlrev_b32 v88, 16, v89
  v_lshlrev_b32 v90, 16, v91
  v_and_b32 v89, 0xffff0000, v89
  v_and_b32 v91, 0xffff0000, v91
  v_mul_f32 v88, 0x3db504f3, v88
  v_mul_f32 v89, 0x3db504f3, v89
  v_mul_f32 v90, 0x3db504f3, v90
  v_mul_f32 v91, 0x3db504f3, v91
  v_cvt_pk_bf16_f32 v89, v88, v89
  v_cvt_pk_bf16_f32 v91, v90, v91
  v_lshlrev_b32 v88, 16, v89
  v_lshlrev_b32 v90, 16, v91
  v_and_b32 v89, 0xffff0000, v89
  v_and_b32 v91, 0xffff0000, v91
  v_max3_f32 v41, v41, v88, v89
  v_max3_f32 v41, v41, v90, v91
  s_waitcnt vmcnt(7)
  v_dot2_f32_bf16 v48, v160, v8, 0
  v_dot2_f32_bf16 v48, v161, v9, v48
  v_dot2_f32_bf16 v48, v162, v10, v48
  v_dot2_f32_bf16 v48, v163, v11, v48
  s_cbranch_vccnz L_h120
  s_waitcnt vmcnt(4)
L_h120:
  buffer_load_dwordx4 v[96:99], v2, s[32:35], s80 offen nt
  s_add_u32 s80, s80, 4096
  s_and_b32 s80, s80, 0x7ffff
  s_waitcnt vmcnt(7)
  v_dot2_f32_bf16 v49, v164, v8, 0
  v_dot2_f32_bf16 v49, v165, v9, v49
  v_dot2_f32_bf16 v49, v166, v10, v49
  v_dot2_f32_bf16 v49, v167, v11, v49
  s_cbranch_vccnz L_h121
  s_waitcnt vmcnt(4)
L_h121:
  buffer_load_dwordx4 v[100:103], v2, s[32:35], s80 offen nt
  s_add_u32 s80, s80, 4096
  s_and_b32 s80, s80, 0x7ffff
  s_waitcnt vmcnt(7)
  v_dot2_f32_bf16 v50, v168, v8, 0
  v_dot2_f32_bf16 v50, v169, v9, v50
  v_dot2_f32_bf16 v50, v170, v10, v50
  v_dot2_f32_bf16 v50, v171, v11, v50
  s_cbranch_vccnz L_h122
  s_waitcnt vmcnt(4)
L_h122:
  buffer_load_dwordx4 v[104:107], v2, s[32:35], s80 offen nt
  s_add_u32 s80, s80, 4096
  s_and_b32 s80, s80, 0x7ffff
  s_waitcnt vmcnt(7)
  v_dot2_f32_bf16 v51, v172, v8, 0
  v_dot2_f32_bf16 v51, v173, v9, v51
  v_dot2_f32_bf16 v51, v174, v10, v51
  v_dot2_f32_bf16 v51, v175, v11, v51
  s_cbranch_vccnz L_h123
  s_waitcnt vmcnt(4)
L_h123:
  buffer_load_dwordx4 v[108:111], v2, s[32:35], s80 offen nt
  s_add_u32 s80, s80, 4096
  s_and_b32 s80, s80, 0x7ffff
  s_waitcnt vmcnt(7)
  v_dot2_f32_bf16 v52, v180, v8, 0
  v_dot2_f32_bf16 v52, v181, v9, v52
  v_dot2_f32_bf16 v52, v182, v10, v52
  v_dot2_f32_bf16 v52, v183, v11, v52
  s_cbranch_vccnz L_h124
  s_waitcnt vmcnt(4)
L_h124:
  buffer_load_dwordx4 v[112:115], v2, s[32:35], s80 offen nt
  s_add_u32 s80, s80, 4096
  s_and_b32 s80, s80, 0x7ffff
  s_waitcnt vmcnt(7)
  v_dot2_f32_bf16 v53, v184, v8, 0
  v_dot2_f32_bf16 v53, v185, v9, v53
  v_dot2_f32_bf16 v53, v186, v10, v53
  v_dot2_f32_bf16 v53, v187, v11, v53
  s_cbranch_vccnz L_h125
  s_waitcnt vmcnt(4)
L_h125:
  buffer_load_dwordx4 v[116:119], v2, s[32:35], s80 offen nt
  s_add_u32 s80, s80, 4096
  s_and_b32 s80, s80, 0x7ffff
  s_waitcnt vmcnt(7)
  v_dot2_f32_bf16 v54, v192, v8, 0
  v_dot2_f32_bf16 v54, v193, v9, v54
  v_dot2_f32_bf16 v54, v194, v10, v54
  v_dot2_f32_bf16 v54, v195, v11, v54
  s_cbranch_vccnz L_h126
  s_waitcnt vmcnt(4)
L_h126:
  buffer_load_dwordx4 v[120:123], v2, s[32:35], s80 offen nt
  s_add_u32 s80, s80, 4096
  s_and_b32 s80, s80, 0x7ffff
  s_waitcnt vmcnt(7)
  v_dot2_f32_bf16 v55, v196, v8, 0
  v_dot2_f32_bf16 v55, v197, v9, v55
  v_dot2_f32_bf16 v55, v198, v10, v55
  v_dot2_f32_bf16 v55, v199, v11, v55
  s_cbranch_vccnz L_h127
  s_waitcnt vmcnt(4)
L_h127:
  buffer_load_dwordx4 v[124:127], v2, s[32:35], s80 offen nt
  s_add_u32 s80, s80, 4096
  s_and_b32 s80, s80, 0x7ffff
  s_waitcnt vmcnt(7)
  v_dot2_f32_bf16 v56, v96, v8, 0
  v_dot2_f32_bf16 v56, v97, v9, v56
  v_dot2_f32_bf16 v56, v98, v10, v56
  v_dot2_f32_bf16 v56, v99, v11, v56
  s_cbranch_vccnz L_h128
  s_waitcnt vmcnt(4)
L_h128:
  buffer_load_dwordx4 v[128:131], v2, s[36:39], s80 offen nt
  s_add_u32 s80, s80, 4096
  s_and_b32 s80, s80, 0x7ffff
  s_waitcnt vmcnt(7)
  v_dot2_f32_bf16 v57, v100, v8, 0
  v_dot2_f32_bf16 v57, v101, v9, v57
  v_dot2_f32_bf16 v57, v102, v10, v57
  v_dot2_f32_bf16 v57, v103, v11, v57
  s_cbranch_vccnz L_h129
  s_waitcnt vmcnt(4)
L_h129:
  buffer_load_dwordx4 v[132:135], v2, s[36:39], s80 offen nt
  s_add_u32 s80, s80, 4096
  s_and_b32 s80, s80, 0x7ffff
  s_waitcnt vmcnt(7)
  v_dot2_f32_bf16 v58, v104, v8, 0
  v_dot2_f32_bf16 v58, v105, v9, v58
  v_dot2_f32_bf16 v58, v106, v10, v58
  v_dot2_f32_bf16 v58, v107, v11, v58
  s_cbranch_vccnz L_h130
  s_waitcnt vmcnt(4)
L_h130:
  buffer_load_dwordx4 v[136:139], v2, s[36:39], s80 offen nt
  s_add_u32 s80, s80, 4096
  s_and_b32 s80, s80, 0x7ffff
  s_waitcnt vmcnt(7)
  v_dot2_f32_bf16 v59, v108, v8, 0
  v_dot2_f32_bf16 v59, v109, v9, v59
  v_dot2_f32_bf16 v59, v110, v10, v59
  v_dot2_f32_bf16 v59, v111, v11, v59
  s_cbranch_vccnz L_h131
  s_waitcnt vmcnt(4)
L_h131:
  buffer_load_dwordx4 v[140:143], v2, s[36:39], s80 offen nt
  s_add_u32 s80, s80, 4096
  s_and_b32 s80, s80, 0x7ffff
  s_waitcnt vmcnt(7)
  v_dot2_f32_bf16 v60, v112, v8, 0
  v_dot2_f32_bf16 v60, v113, v9, v60
  v_dot2_f32_bf16 v60, v114, v10, v60
  v_dot2_f32_bf16 v60, v115, v11, v60
  s_cbranch_vccnz L_h132
  s_waitcnt vmcnt(4)
L_h132:
  buffer_load_dwordx4 v[144:147], v2, s[36:39], s80 offen nt
  s_add_u32 s80, s80, 4096
  s_and_b32 s80, s80, 0x7ffff
  s_waitcnt vmcnt(7)
  v_dot2_f32_bf16 v61, v116, v8, 0
  v_dot2_f32_bf16 v61, v117, v9, v61
  v_dot2_f32_bf16 v61, v118, v10, v61
  v_dot2_f32_bf16 v61, v119, v11, v61
  s_cbranch_vccnz L_h133
  s_waitcnt vmcnt(4)
L_h133:
  buffer_load_dwordx4 v[148:151], v2, s[36:39], s80 offen nt
  s_add_u32 s80, s80, 4096
  s_and_b32 s80, s80, 0x7ffff
  s_waitcnt vmcnt(7)
  v_dot2_f32_bf16 v62, v120, v8, 0
  v_dot2_f32_bf16 v62, v121, v9, v62
  v_dot2_f32_bf16 v62, v122, v10, v62
  v_dot2_f32_bf16 v62, v123, v11, v62
  s_cbranch_vccnz L_h134
  s_waitcnt vmcnt(4)
L_h134:
  buffer_load_dwordx4 v[176:179], v2, s[36:39], s80 offen nt
  s_add_u32 s80, s80, 4096
  s_and_b32 s80, s80, 0x7ffff
  s_waitcnt vmcnt(7)
  v_dot2_f32_bf16 v63, v124, v8, 0
  v_dot2_f32_bf16 v63, v125, v9, v63
  v_dot2_f32_bf16 v63, v126, v10, v63
  v_dot2_f32_bf16 v63, v127, v11, v63
  s_cbranch_vccnz L_h135
  s_waitcnt vmcnt(4)
L_h135:
  buffer_load_dwordx4 v[204:207], v2, s[36:39], s80 offen nt
  s_add_u32 s80, s80, 4096
  s_and_b32 s80, s80, 0x7ffff
  v_add_f32_dpp v48, v48, v48 row_mirror row_mask:0xf bank_mask:0x3
  s_nop 1
  v_add_f32_dpp v48, v56, v56 row_mirror row_mask:0xf bank_mask:0xc
  v_add_f32_dpp v49, v49, v49 row_mirror row_mask:0xf bank_mask:0x3
  s_nop 1
  v_add_f32_dpp v49, v57, v57 row_mirror row_mask:0xf bank_mask:0xc
  v_add_f32_dpp v50, v50, v50 row_mirror row_mask:0xf bank_mask:0x3
  s_nop 1
  v_add_f32_dpp v50, v58, v58 row_mirror row_mask:0xf bank_mask:0xc
  v_add_f32_dpp v51, v51, v51 row_mirror row_mask:0xf bank_mask:0x3
  s_nop 1
  v_add_f32_dpp v51, v59, v59 row_mirror row_mask:0xf bank_mask:0xc
  v_add_f32_dpp v52, v52, v52 row_mirror row_mask:0xf bank_mask:0x3
  s_nop 1
  v_add_f32_dpp v52, v60, v60 row_mirror row_mask:0xf bank_mask:0xc
  v_add_f32_dpp v53, v53, v53 row_mirror row_mask:0xf bank_mask:0x3
  s_nop 1
  v_add_f32_dpp v53, v61, v61 row_mirror row_mask:0xf bank_mask:0xc
  v_add_f32_dpp v54, v54, v54 row_mirror row_mask:0xf bank_mask:0x3
  s_nop 1
  v_add_f32_dpp v54, v62, v62 row_mirror row_mask:0xf bank_mask:0xc
  v_add_f32_dpp v55, v55, v55 row_mirror row_mask:0xf bank_mask:0x3
  s_nop 1
  v_add_f32_dpp v55, v63, v63 row_mirror row_mask:0xf bank_mask:0xc
  v_add_f32_dpp v48, v48, v48 row_half_mirror row_mask:0xf bank_mask:0x5
  s_nop 1
  v_add_f32_dpp v48, v52, v52 row_half_mirror row_mask:0xf bank_mask:0xa
  v_add_f32_dpp v49, v49, v49 row_half_mirror row_mask:0xf bank_mask:0x5
  s_nop 1
  v_add_f32_dpp v49, v53, v53 row_half_mirror row_mask:0xf bank_mask:0xa
  v_add_f32_dpp v50, v50, v50 row_half_mirror row_mask:0xf bank_mask:0x5
  s_nop 1
  v_add_f32_dpp v50, v54, v54 row_half_mirror row_mask:0xf bank_mask:0xa
  v_add_f32_dpp v51, v51, v51 row_half_mirror row_mask:0xf bank_mask:0x5
  s_nop 1
  v_add_f32_dpp v51, v55, v55 row_half_mirror row_mask:0xf bank_mask:0xa
  v_add_f32_dpp v48, v48, v48 quad_perm:[2,3,0,1] row_mask:0xf bank_mask:0xf
  v_add_f32_dpp v49, v49, v49 quad_perm:[2,3,0,1] row_mask:0xf bank_mask:0xf
  v_add_f32_dpp v50, v50, v50 quad_perm:[2,3,0,1] row_mask:0xf bank_mask:0xf
  v_add_f32_dpp v51, v51, v51 quad_perm:[2,3,0,1] row_mask:0xf bank_mask:0xf
  v_add_f32_dpp v92, v48, v48 quad_perm:[1,0,3,2] row_mask:0xf bank_mask:0xf
  v_add_f32_dpp v93, v49, v49 quad_perm:[1,0,3,2] row_mask:0xf bank_mask:0xf
  v_add_f32_dpp v94, v50, v50 quad_perm:[1,0,3,2] row_mask:0xf bank_mask:0xf
  v_add_f32_dpp v95, v51, v51 quad_perm:[1,0,3,2] row_mask:0xf bank_mask:0xf
  v_cvt_pk_bf16_f32 v93, v92, v93
  v_cvt_pk_bf16_f32 v95, v94, v95
  v_lshlrev_b32 v92, 16, v93
  v_lshlrev_b32 v94, 16, v95
  v_and_b32 v93, 0xffff0000, v93
  v_and_b32 v95, 0xffff0000, v95
  v_mul_f32 v92, 0x3db504f3, v92
  v_mul_f32 v93, 0x3db504f3, v93
  v_mul_f32 v94, 0x3db504f3, v94
  v_mul_f32 v95, 0x3db504f3, v95
  v_cvt_pk_bf16_f32 v93, v92, v93
  v_cvt_pk_bf16_f32 v95, v94, v95
  v_lshlrev_b32 v92, 16, v93
  v_lshlrev_b32 v94, 16, v95
  v_and_b32 v93, 0xffff0000, v93
  v_and_b32 v95, 0xffff0000, v95
  v_max3_f32 v41, v41, v92, v93
  v_max3_f32 v41, v41, v94, v95
  s_nop 1
  v_max_f32_dpp v41, v41, v41 row_ror:4 row_mask:0xf bank_mask:0xf
  s_nop 1
  v_max_f32_dpp v41, v41, v41 row_ror:8 row_mask:0xf bank_mask:0xf
  v_mov_b32 v12, v41
  s_nop 1
  v_permlane16_swap_b32 v41, v12
  v_max_f32 v41, v41, v12
  v_mov_b32 v12, v41
  s_nop 1
  v_permlane32_swap_b32 v41, v12
  v_max_f32 v41, v41, v12
  s_mov_b32 s93, 0x3fb8aa3b
  v_mul_f32 v41, s93, v41
  v_mov_b32 v46, 0
  v_mov_b32 v45, 0
  v_fma_f32 v64, v64, s93, -v41
  v_fma_f32 v65, v65, s93, -v41
  v_fma_f32 v66, v66, s93, -v41
  v_fma_f32 v67, v67, s93, -v41
  v_exp_f32 v64, v64
  v_exp_f32 v65, v65
  v_exp_f32 v66, v66
  v_exp_f32 v67, v67
  v_add_f32 v46, v46, v64
  v_add_f32 v45, v45, v65
  v_add_f32 v46, v46, v66
  v_add_f32 v45, v45, v67
  v_cvt_pk_bf16_f32 v64, v64, v64
  v_cvt_pk_bf16_f32 v65, v65, v65
  v_cvt_pk_bf16_f32 v66, v66, v66
  v_cvt_pk_bf16_f32 v67, v67, v67
  v_fma_f32 v68, v68, s93, -v41
  v_fma_f32 v69, v69, s93, -v41
  v_fma_f32 v70, v70, s93, -v41
  v_fma_f32 v71, v71, s93, -v41
  v_exp_f32 v68, v68
  v_exp_f32 v69, v69
  v_exp_f32 v70, v70
  v_exp_f32 v71, v71
  v_add_f32 v46, v46, v68
  v_add_f32 v45, v45, v69
  v_add_f32 v46, v46, v70
  v_add_f32 v45, v45, v71
  v_cvt_pk_bf16_f32 v68, v68, v68
  v_cvt_pk_bf16_f32 v69, v69, v69
  v_cvt_pk_bf16_f32 v70, v70, v70
  v_cvt_pk_bf16_f32 v71, v71, v71
  v_fma_f32 v72, v72, s93, -v41
  v_fma_f32 v73, v73, s93, -v41
  v_fma_f32 v74, v74, s93, -v41
  v_fma_f32 v75, v75, s93, -v41
  v_exp_f32 v72, v72
  v_exp_f32 v73, v73
  v_exp_f32 v74, v74
  v_exp_f32 v75, v75
  v_add_f32 v46, v46, v72
  v_add_f32 v45, v45, v73
  v_add_f32 v46, v46, v74
  v_add_f32 v45, v45, v75
  v_cvt_pk_bf16_f32 v72, v72, v72
  v_cvt_pk_bf16_f32 v73, v73, v73
  v_cvt_pk_bf16_f32 v74, v74, v74
  v_cvt_pk_bf16_f32 v75, v75, v75
  s_cbranch_vccnz L_h136
  s_waitcnt vmcnt(4)
L_h136:
  s_waitcnt vmcnt(7)
  buffer_load_dwordx4 v[232:235], v2, s[36:39], s80 offen nt
  s_add_u32 s80, s80, 4096
  s_and_b32 s80, s80, 0x7ffff
  v_fma_f32 v76, v76, s93, -v41
  v_fma_f32 v77, v77, s93, -v41
  v_fma_f32 v78, v78, s93, -v41
  v_fma_f32 v79, v79, s93, -v41
  v_exp_f32 v76, v76
  v_exp_f32 v77, v77
  v_exp_f32 v78, v78
  v_exp_f32 v79, v79
  v_add_f32 v46, v46, v76
  v_add_f32 v45, v45, v77
  v_add_f32 v46, v46, v78
  v_add_f32 v45, v45, v79
  v_cvt_pk_bf16_f32 v76, v76, v76
  v_cvt_pk_bf16_f32 v77, v77, v77
  v_cvt_pk_bf16_f32 v78, v78, v78
  v_cvt_pk_bf16_f32 v79, v79, v79
  v_fma_f32 v80, v80, s93, -v41
  v_fma_f32 v81, v81, s93, -v41
  v_fma_f32 v82, v82, s93, -v41
  v_fma_f32 v83, v83, s93, -v41
  v_exp_f32 v80, v80
  v_exp_f32 v81, v81
  v_exp_f32 v82, v82
  v_exp_f32 v83, v83
  v_add_f32 v46, v46, v80
  v_add_f32 v45, v45, v81
  v_add_f32 v46, v46, v82
  v_add_f32 v45, v45, v83
  v_cvt_pk_bf16_f32 v80, v80, v80
  v_cvt_pk_bf16_f32 v81, v81, v81
  v_cvt_pk_bf16_f32 v82, v82, v82
  v_cvt_pk_bf16_f32 v83, v83, v83
  v_fma_f32 v84, v84, s93, -v41
  v_fma_f32 v85, v85, s93, -v41
  v_fma_f32 v86, v86, s93, -v41
  v_fma_f32 v87, v87, s93, -v41
  v_exp_f32 v84, v84
  v_exp_f32 v85, v85
  v_exp_f32 v86, v86
  v_exp_f32 v87, v87
  v_add_f32 v46, v46, v84
  v_add_f32 v45, v45, v85
  v_add_f32 v46, v46, v86
  v_add_f32 v45, v45, v87
  v_cvt_pk_bf16_f32 v84, v84, v84
  v_cvt_pk_bf16_f32 v85, v85, v85
  v_cvt_pk_bf16_f32 v86, v86, v86
  v_cvt_pk_bf16_f32 v87, v87, v87
  s_cbranch_vccnz L_h137
  s_waitcnt vmcnt(4)
L_h137:
  s_waitcnt vmcnt(7)
  buffer_load_dwordx4 v[156:159], v2, s[36:39], s80 offen nt
  s_add_u32 s80, s80, 4096
  s_and_b32 s80, s80, 0x7ffff
  v_fma_f32 v88, v88, s93, -v41
  v_fma_f32 v89, v89, s93, -v41
  v_fma_f32 v90, v90, s93, -v41
  v_fma_f32 v91, v91, s93, -v41
  v_exp_f32 v88, v88
  v_exp_f32 v89, v89
  v_exp_f32 v90, v90
  v_exp_f32 v91, v91
  v_add_f32 v46, v46, v88
  v_add_f32 v45, v45, v89
  v_add_f32 v46, v46, v90
  v_add_f32 v45, v45, v91
  v_cvt_pk_bf16_f32 v88, v88, v88
  v_cvt_pk_bf16_f32 v89, v89, v89
  v_cvt_pk_bf16_f32 v90, v90, v90
  v_cvt_pk_bf16_f32 v91, v91, v91
  v_fma_f32 v92, v92, s93, -v41
  v_fma_f32 v93, v93, s93, -v41
  v_fma_f32 v94, v94, s93, -v41
  v_fma_f32 v95, v95, s93, -v41
  v_exp_f32 v92, v92
  v_exp_f32 v93, v93
  v_exp_f32 v94, v94
  v_exp_f32 v95, v95
  v_add_f32 v46, v46, v92
  v_add_f32 v45, v45, v93
  v_add_f32 v46, v46, v94
  v_add_f32 v45, v45, v95
  v_cvt_pk_bf16_f32 v92, v92, v92
  v_cvt_pk_bf16_f32 v93, v93, v93
  v_cvt_pk_bf16_f32 v94, v94, v94
  v_cvt_pk_bf16_f32 v95, v95, v95
  v_add_f32 v47, v46, v45
  s_nop 1
  v_add_f32_dpp v47, v47, v47 row_ror:4 row_mask:0xf bank_mask:0xf
  s_nop 1
  v_add_f32_dpp v47, v47, v47 row_ror:8 row_mask:0xf bank_mask:0xf
  v_mov_b32 v12, v47
  s_nop 1
  v_permlane16_swap_b32 v47, v12
  v_add_f32 v47, v47, v12
  v_mov_b32 v12, v47
  s_nop 1
  v_permlane32_swap_b32 v47, v12
  v_add_f32 v47, v47, v12
  v_mov_b32 v46, v41
  s_lshl_b32 s77, s68, 3
  v_mov_b32 v12, s77
  ds_write_b64 v12, v[46:47] offset:28672
  v_mov_b32 v12, 1
  ds_add_u32 v13, v12 offset:28704
  v_and_b32_dpp v20, v64, v4 row_newbcast:0 row_mask:0xf bank_mask:0xf
  v_and_b32_dpp v21, v64, v5 row_newbcast:0 row_mask:0xf bank_mask:0xf
  v_and_b32_dpp v22, v64, v6 row_newbcast:0 row_mask:0xf bank_mask:0xf
  v_and_b32_dpp v23, v64, v7 row_newbcast:0 row_mask:0xf bank_mask:0xf
  s_nop 1
  v_mfma_f32_16x16x32_bf16 v[16:19], v[20:23], v[128:131], 0
  v_and_b32_dpp v24, v65, v4 row_newbcast:0 row_mask:0xf bank_mask:0xf
  v_and_b32_dpp v25, v65, v5 row_newbcast:0 row_mask:0xf bank_mask:0xf
  v_and_b32_dpp v26, v65, v6 row_newbcast:0 row_mask:0xf bank_mask:0xf
  v_and_b32_dpp v27, v65, v7 row_newbcast:0 row_mask:0xf bank_mask:0xf
  s_nop 1
  v_mfma_f32_16x16x32_bf16 v[16:19], v[24:27], v[132:135], v[16:19]
  v_and_b32_dpp v20, v66, v4 row_newbcast:0 row_mask:0xf bank_mask:0xf
  v_and_b32_dpp v21, v66, v5 row_newbcast:0 row_mask:0xf bank_mask:0xf
  v_and_b32_dpp v22, v66, v6 row_newbcast:0 row_mask:0xf bank_mask:0xf
  v_and_b32_dpp v23, v66, v7 row_newbcast:0 row_mask:0xf bank_mask:0xf
  s_waitcnt vmcnt(7)
  s_nop 0
  v_mfma_f32_16x16x32_bf16 v[16:19], v[20:23], v[136:139], v[16:19]
  s_cbranch_vccnz L_h138
  s_waitcnt vmcnt(4)
L_h138:
  buffer_load_dwordx4 v[188:191], v2, s[36:39], s80 offen nt
  s_add_u32 s80, s80, 4096
  s_and_b32 s80, s80, 0x7ffff
  v_and_b32_dpp v24, v67, v4 row_newbcast:0 row_mask:0xf bank_mask:0xf
  v_and_b32_dpp v25, v67, v5 row_newbcast:0 row_mask:0xf bank_mask:0xf
  v_and_b32_dpp v26, v67, v6 row_newbcast:0 row_mask:0xf bank_mask:0xf
  v_and_b32_dpp v27, v67, v7 row_newbcast:0 row_mask:0xf bank_mask:0xf
  s_waitcnt vmcnt(7)
  s_nop 0
  v_mfma_f32_16x16x32_bf16 v[16:19], v[24:27], v[140:143], v[16:19]
  s_cbranch_vccnz L_h139
  s_waitcnt vmcnt(4)
L_h139:
  buffer_load_dwordx4 v[200:203], v2, s[36:39], s80 offen nt
  s_add_u32 s80, s80, 4096
  s_and_b32 s80, s80, 0x7ffff
  v_and_b32_dpp v20, v64, v4 row_newbcast:4 row_mask:0xf bank_mask:0xf
  v_and_b32_dpp v21, v64, v5 row_newbcast:4 row_mask:0xf bank_mask:0xf
  v_and_b32_dpp v22, v64, v6 row_newbcast:4 row_mask:0xf bank_mask:0xf
  v_and_b32_dpp v23, v64, v7 row_newbcast:4 row_mask:0xf bank_mask:0xf
  s_waitcnt vmcnt(7)
  s_nop 0
  v_mfma_f32_16x16x32_bf16 v[16:19], v[20:23], v[144:147], v[16:19]
  s_waitcnt vmcnt(4)
  buffer_load_dwordx4 v[208:211], v2, s[36:39], s80 offen nt
  s_add_u32 s80, s80, 4096
  s_and_b32 s80, s80, 0x7ffff
  v_and_b32_dpp v24, v65, v4 row_newbcast:4 row_mask:0xf bank_mask:0xf
  v_and_b32_dpp v25, v65, v5 row_newbcast:4 row_mask:0xf bank_mask:0xf
  v_and_b32_dpp v26, v65, v6 row_newbcast:4 row_mask:0xf bank_mask:0xf
  v_and_b32_dpp v27, v65, v7 row_newbcast:4 row_mask:0xf bank_mask:0xf
  s_nop 1
  v_mfma_f32_16x16x32_bf16 v[16:19], v[24:27], v[148:151], v[16:19]
  s_waitcnt vmcnt(4)
  buffer_load_dwordx4 v[212:215], v2, s[36:39], s80 offen nt
  s_add_u32 s80, s80, 4096
  s_and_b32 s80, s80, 0x7ffff
  v_and_b32_dpp v20, v66, v4 row_newbcast:4 row_mask:0xf bank_mask:0xf
  v_and_b32_dpp v21, v66, v5 row_newbcast:4 row_mask:0xf bank_mask:0xf
  v_and_b32_dpp v22, v66, v6 row_newbcast:4 row_mask:0xf bank_mask:0xf
  v_and_b32_dpp v23, v66, v7 row_newbcast:4 row_mask:0xf bank_mask:0xf
  s_nop 1
  v_mfma_f32_16x16x32_bf16 v[16:19], v[20:23], v[176:179], v[16:19]
  s_waitcnt vmcnt(4)
  buffer_load_dwordx4 v[216:219], v2, s[36:39], s80 offen nt
  s_add_u32 s80, s80, 4096
  s_and_b32 s80, s80, 0x7ffff
  v_and_b32_dpp v24, v67, v4 row_newbcast:4 row_mask:0xf bank_mask:0xf
  v_and_b32_dpp v25, v67, v5 row_newbcast:4 row_mask:0xf bank_mask:0xf
  v_and_b32_dpp v26, v67, v6 row_newbcast:4 row_mask:0xf bank_mask:0xf
  v_and_b32_dpp v27, v67, v7 row_newbcast:4 row_mask:0xf bank_mask:0xf
  s_nop 1
  v_mfma_f32_16x16x32_bf16 v[16:19], v[24:27], v[204:207], v[16:19]
  s_waitcnt vmcnt(4)
  buffer_load_dwordx4 v[220:223], v2, s[36:39], s80 offen nt
  s_add_u32 s80, s80, 4096
  s_and_b32 s80, s80, 0x7ffff
  v_and_b32_dpp v20, v64, v4 row_newbcast:8 row_mask:0xf bank_mask:0xf
  v_and_b32_dpp v21, v64, v5 row_newbcast:8 row_mask:0xf bank_mask:0xf
  v_and_b32_dpp v22, v64, v6 row_newbcast:8 row_mask:0xf bank_mask:0xf
  v_and_b32_dpp v23, v64, v7 row_newbcast:8 row_mask:0xf bank_mask:0xf
  s_nop 1
  v_mfma_f32_16x16x32_bf16 v[16:19], v[20:23], v[232:235], v[16:19]
  s_waitcnt vmcnt(4)
  buffer_load_dwordx4 v[224:227], v2, s[36:39], s80 offen nt
  s_add_u32 s80, s80, 4096
  s_and_b32 s80, s80, 0x7ffff
  v_and_b32_dpp v24, v65, v4 row_newbcast:8 row_mask:0xf bank_mask:0xf
  v_and_b32_dpp v25, v65, v5 row_newbcast:8 row_mask:0xf bank_mask:0xf
  v_and_b32_dpp v26, v65, v6 row_newbcast:8 row_mask:0xf bank_mask:0xf
  v_and_b32_dpp v27, v65, v7 row_newbcast:8 row_mask:0xf bank_mask:0xf
  s_nop 1
  v_mfma_f32_16x16x32_bf16 v[16:19], v[24:27], v[156:159], v[16:19]
  s_waitcnt vmcnt(4)
  buffer_load_dwordx4 v[228:231], v2, s[36:39], s80 offen nt
  s_add_u32 s80, s80, 4096
  s_and_b32 s80, s80, 0x7ffff
  v_and_b32_dpp v20, v66, v4 row_newbcast:8 row_mask:0xf bank_mask:0xf
  v_and_b32_dpp v21, v66, v5 row_newbcast:8 row_mask:0xf bank_mask:0xf
  v_and_b32_dpp v22, v66, v6 row_newbcast:8 row_mask:0xf bank_mask:0xf
  v_and_b32_dpp v23, v66, v7 row_newbcast:8 row_mask:0xf bank_mask:0xf
  s_nop 1
  v_mfma_f32_16x16x32_bf16 v[16:19], v[20:23], v[188:191], v[16:19]
  s_waitcnt vmcnt(4)
  buffer_load_dwordx4 v[236:239], v2, s[36:39], s80 offen nt
  s_add_u32 s80, s80, 4096
  s_and_b32 s80, s80, 0x7ffff
  v_and_b32_dpp v24, v67, v4 row_newbcast:8 row_mask:0xf bank_mask:0xf
  v_and_b32_dpp v25, v67, v5 row_newbcast:8 row_mask:0xf bank_mask:0xf
  v_and_b32_dpp v26, v67, v6 row_newbcast:8 row_mask:0xf bank_mask:0xf
  v_and_b32_dpp v27, v67, v7 row_newbcast:8 row_mask:0xf bank_mask:0xf
  s_nop 1
  v_mfma_f32_16x16x32_bf16 v[16:19], v[24:27], v[200:203], v[16:19]
  s_waitcnt vmcnt(4)
  buffer_load_dwordx4 v[240:243], v2, s[36:39], s80 offen nt
  s_add_u32 s80, s80, 4096
  s_and_b32 s80, s80, 0x7ffff
  v_and_b32_dpp v20, v64, v4 row_newbcast:12 row_mask:0xf bank_mask:0xf
  v_and_b32_dpp v21, v64, v5 row_newbcast:12 row_mask:0xf bank_mask:0xf
  v_and_b32_dpp v22, v64, v6 row_newbcast:12 row_mask:0xf bank_mask:0xf
  v_and_b32_dpp v23, v64, v7 row_newbcast:12 row_mask:0xf bank_mask:0xf
  s_nop 1
  v_mfma_f32_16x16x32_bf16 v[16:19], v[20:23], v[208:211], v[16:19]
  s_waitcnt vmcnt(4)
  buffer_load_dwordx4 v[244:247], v2, s[36:39], s80 offen nt
  s_add_u32 s80, s80, 4096
  s_and_b32 s80, s80, 0x7ffff
  v_and_b32_dpp v24, v65, v4 row_newbcast:12 row_mask:0xf bank_mask:0xf
  v_and_b32_dpp v25, v65, v5 row_newbcast:12 row_mask:0xf bank_mask:0xf
  v_and_b32_dpp v26, v65, v6 row_newbcast:12 row_mask:0xf bank_mask:0xf
  v_and_b32_dpp v27, v65, v7 row_newbcast:12 row_mask:0xf bank_mask:0xf
  s_nop 1
  v_mfma_f32_16x16x32_bf16 v[16:19], v[24:27], v[212:215], v[16:19]
  s_waitcnt vmcnt(4)
  buffer_load_dwordx4 v[248:251], v2, s[36:39], s80 offen nt
  s_add_u32 s80, s80, 4096
  s_and_b32 s80, s80, 0x7ffff
  v_and_b32_dpp v20, v66, v4 row_newbcast:12 row_mask:0xf bank_mask:0xf
  v_and_b32_dpp v21, v66, v5 row_newbcast:12 row_mask:0xf bank_mask:0xf
  v_and_b32_dpp v22, v66, v6 row_newbcast:12 row_mask:0xf bank_mask:0xf
  v_and_b32_dpp v23, v66, v7 row_newbcast:12 row_mask:0xf bank_mask:0xf
  s_nop 1
  v_mfma_f32_16x16x32_bf16 v[16:19], v[20:23], v[216:219], v[16:19]
  s_waitcnt vmcnt(4)
  buffer_load_dwordx4 v[252:255], v2, s[36:39], s80 offen nt
  s_add_u32 s80, s80, 4096
  s_and_b32 s80, s80, 0x7ffff
  v_and_b32_dpp v24, v67, v4 row_newbcast:12 row_mask:0xf bank_mask:0xf
  v_and_b32_dpp v25, v67, v5 row_newbcast:12 row_mask:0xf bank_mask:0xf
  v_and_b32_dpp v26, v67, v6 row_newbcast:12 row_mask:0xf bank_mask:0xf
  v_and_b32_dpp v27, v67, v7 row_newbcast:12 row_mask:0xf bank_mask:0xf
  s_nop 1
  v_mfma_f32_16x16x32_bf16 v[16:19], v[24:27], v[220:223], v[16:19]
  s_waitcnt vmcnt(4)
  buffer_load_dwordx4 v[152:155], v2, s[36:39], s80 offen nt
  s_add_u32 s80, s80, 4096
  s_and_b32 s80, s80, 0x7ffff
  v_and_b32_dpp v20, v68, v4 row_newbcast:0 row_mask:0xf bank_mask:0xf
  v_and_b32_dpp v21, v68, v5 row_newbcast:0 row_mask:0xf bank_mask:0xf
  v_and_b32_dpp v22, v68, v6 row_newbcast:0 row_mask:0xf bank_mask:0xf
  v_and_b32_dpp v23, v68, v7 row_newbcast:0 row_mask:0xf bank_mask:0xf
  s_nop 1
  v_mfma_f32_16x16x32_bf16 v[16:19], v[20:23], v[224:227], v[16:19]
  s_waitcnt vmcnt(4)
  buffer_load_dwordx4 v[160:163], v2, s[36:39], s80 offen nt
  s_add_u32 s80, s80, 4096
  s_and_b32 s80, s80, 0x7ffff
  v_and_b32_dpp v24, v69, v4 row_newbcast:0 row_mask:0xf bank_mask:0xf
  v_and_b32_dpp v25, v69, v5 row_newbcast:0 row_mask:0xf bank_mask:0xf
  v_and_b32_dpp v26, v69, v6 row_newbcast:0 row_mask:0xf bank_mask:0xf
  v_and_b32_dpp v27, v69, v7 row_newbcast:0 row_mask:0xf bank_mask:0xf
  s_nop 1
  v_mfma_f32_16x16x32_bf16 v[16:19], v[24:27], v[228:231], v[16:19]
  s_waitcnt vmcnt(4)
  buffer_load_dwordx4 v[164:167], v2, s[36:39], s80 offen nt
  s_add_u32 s80, s80, 4096
  s_and_b32 s80, s80, 0x7ffff
  v_and_b32_dpp v20, v70, v4 row_newbcast:0 row_mask:0xf bank_mask:0xf
  v_and_b32_dpp v21, v70, v5 row_newbcast:0 row_mask:0xf bank_mask:0xf
  v_and_b32_dpp v22, v70, v6 row_newbcast:0 row_mask:0xf bank_mask:0xf
  v_and_b32_dpp v23, v70, v7 row_newbcast:0 row_mask:0xf bank_mask:0xf
  s_nop 1
  v_mfma_f32_16x16x32_bf16 v[16:19], v[20:23], v[236:239], v[16:19]
  s_waitcnt vmcnt(4)
  buffer_load_dwordx4 v[168:171], v2, s[36:39], s80 offen nt
  s_add_u32 s80, s80, 4096
  s_and_b32 s80, s80, 0x7ffff
  v_and_b32_dpp v24, v71, v4 row_newbcast:0 row_mask:0xf bank_mask:0xf
  v_and_b32_dpp v25, v71, v5 row_newbcast:0 row_mask:0xf bank_mask:0xf
  v_and_b32_dpp v26, v71, v6 row_newbcast:0 row_mask:0xf bank_mask:0xf
  v_and_b32_dpp v27, v71, v7 row_newbcast:0 row_mask:0xf bank_mask:0xf
  s_nop 1
  v_mfma_f32_16x16x32_bf16 v[16:19], v[24:27], v[240:243], v[16:19]
  s_waitcnt vmcnt(4)
  buffer_load_dwordx4 v[172:175], v2, s[36:39], s80 offen nt
  s_add_u32 s80, s80, 4096
  s_and_b32 s80, s80, 0x7ffff
  v_and_b32_dpp v20, v68, v4 row_newbcast:4 row_mask:0xf bank_mask:0xf
  v_and_b32_dpp v21, v68, v5 row_newbcast:4 row_mask:0xf bank_mask:0xf
  v_and_b32_dpp v22, v68, v6 row_newbcast:4 row_mask:0xf bank_mask:0xf
  v_and_b32_dpp v23, v68, v7 row_newbcast:4 row_mask:0xf bank_mask:0xf
  s_nop 1
  v_mfma_f32_16x16x32_bf16 v[16:19], v[20:23], v[244:247], v[16:19]
  s_waitcnt vmcnt(4)
  buffer_load_dwordx4 v[180:183], v2, s[36:39], s80 offen nt
  s_add_u32 s80, s80, 4096
  s_and_b32 s80, s80, 0x7ffff
  v_and_b32_dpp v24, v69, v4 row_newbcast:4 row_mask:0xf bank_mask:0xf
  v_and_b32_dpp v25, v69, v5 row_newbcast:4 row_mask:0xf bank_mask:0xf
  v_and_b32_dpp v26, v69, v6 row_newbcast:4 row_mask:0xf bank_mask:0xf
  v_and_b32_dpp v27, v69, v7 row_newbcast:4 row_mask:0xf bank_mask:0xf
  s_nop 1
  v_mfma_f32_16x16x32_bf16 v[16:19], v[24:27], v[248:251], v[16:19]
  s_waitcnt vmcnt(4)
  buffer_load_dwordx4 v[184:187], v2, s[36:39], s80 offen nt
  s_add_u32 s80, s80, 4096
  s_and_b32 s80, s80, 0x7ffff
  v_and_b32_dpp v20, v70, v4 row_newbcast:4 row_mask:0xf bank_mask:0xf
  v_and_b32_dpp v21, v70, v5 row_newbcast:4 row_mask:0xf bank_mask:0xf
  v_and_b32_dpp v22, v70, v6 row_newbcast:4 row_mask:0xf bank_mask:0xf
  v_and_b32_dpp v23, v70, v7 row_newbcast:4 row_mask:0xf bank_mask:0xf
  s_nop 1
  v_mfma_f32_16x16x32_bf16 v[16:19], v[20:23], v[252:255], v[16:19]
  s_waitcnt vmcnt(4)
  buffer_load_dwordx4 v[192:195], v2, s[36:39], s80 offen nt
  s_add_u32 s80, s80, 4096
  s_and_b32 s80, s80, 0x7ffff
  v_and_b32_dpp v24, v71, v4 row_newbcast:4 row_mask:0xf bank_mask:0xf
  v_and_b32_dpp v25, v71, v5 row_newbcast:4 row_mask:0xf bank_mask:0xf
  v_and_b32_dpp v26, v71, v6 row_newbcast:4 row_mask:0xf bank_mask:0xf
  v_and_b32_dpp v27, v71, v7 row_newbcast:4 row_mask:0xf bank_mask:0xf
  s_nop 1
  v_mfma_f32_16x16x32_bf16 v[16:19], v[24:27], v[152:155], v[16:19]
  s_waitcnt vmcnt(4)
  buffer_load_dwordx4 v[196:199], v2, s[36:39], s80 offen nt
  s_add_u32 s80, s80, 4096
  s_and_b32 s80, s80, 0x7ffff
  v_and_b32_dpp v20, v68, v4 row_newbcast:8 row_mask:0xf bank_mask:0xf
  v_and_b32_dpp v21, v68, v5 row_newbcast:8 row_mask:0xf bank_mask:0xf
  v_and_b32_dpp v22, v68, v6 row_newbcast:8 row_mask:0xf bank_mask:0xf
  v_and_b32_dpp v23, v68, v7 row_newbcast:8 row_mask:0xf bank_mask:0xf
  s_nop 1
  v_mfma_f32_16x16x32_bf16 v[16:19], v[20:23], v[160:163], v[16:19]
  s_waitcnt vmcnt(4)
  buffer_load_dwordx4 v[96:99], v2, s[36:39], s80 offen nt
  s_add_u32 s80, s80, 4096
  s_and_b32 s80, s80, 0x7ffff
  v_and_b32_dpp v24, v69, v4 row_newbcast:8 row_mask:0xf bank_mask:0xf
  v_and_b32_dpp v25, v69, v5 row_newbcast:8 row_mask:0xf bank_mask:0xf
  v_and_b32_dpp v26, v69, v6 row_newbcast:8 row_mask:0xf bank_mask:0xf
  v_and_b32_dpp v27, v69, v7 row_newbcast:8 row_mask:0xf bank_mask:0xf
  s_nop 1
  v_mfma_f32_16x16x32_bf16 v[16:19], v[24:27], v[164:167], v[16:19]
  s_waitcnt vmcnt(4)
  buffer_load_dwordx4 v[100:103], v2, s[36:39], s80 offen nt
  s_add_u32 s80, s80, 4096
  s_and_b32 s80, s80, 0x7ffff
  v_and_b32_dpp v20, v70, v4 row_newbcast:8 row_mask:0xf bank_mask:0xf
  v_and_b32_dpp v21, v70, v5 row_newbcast:8 row_mask:0xf bank_mask:0xf
  v_and_b32_dpp v22, v70, v6 row_newbcast:8 row_mask:0xf bank_mask:0xf
  v_and_b32_dpp v23, v70, v7 row_newbcast:8 row_mask:0xf bank_mask:0xf
  s_nop 1
  v_mfma_f32_16x16x32_bf16 v[16:19], v[20:23], v[168:171], v[16:19]
  s_waitcnt vmcnt(4)
  buffer_load_dwordx4 v[104:107], v2, s[36:39], s80 offen nt
  s_add_u32 s80, s80, 4096
  s_and_b32 s80, s80, 0x7ffff
  v_and_b32_dpp v24, v71, v4 row_newbcast:8 row_mask:0xf bank_mask:0xf
  v_and_b32_dpp v25, v71, v5 row_newbcast:8 row_mask:0xf bank_mask:0xf
  v_and_b32_dpp v26, v71, v6 row_newbcast:8 row_mask:0xf bank_mask:0xf
  v_and_b32_dpp v27, v71, v7 row_newbcast:8 row_mask:0xf bank_mask:0xf
  s_nop 1
  v_mfma_f32_16x16x32_bf16 v[16:19], v[24:27], v[172:175], v[16:19]
  s_waitcnt vmcnt(4)
  buffer_load_dwordx4 v[108:111], v2, s[36:39], s80 offen nt
  s_add_u32 s80, s80, 4096
  s_and_b32 s80, s80, 0x7ffff
  v_and_b32_dpp v20, v68, v4 row_newbcast:12 row_mask:0xf bank_mask:0xf
  v_and_b32_dpp v21, v68, v5 row_newbcast:12 row_mask:0xf bank_mask:0xf
  v_and_b32_dpp v22, v68, v6 row_newbcast:12 row_mask:0xf bank_mask:0xf
  v_and_b32_dpp v23, v68, v7 row_newbcast:12 row_mask:0xf bank_mask:0xf
  s_nop 1
  v_mfma_f32_16x16x32_bf16 v[16:19], v[20:23], v[180:183], v[16:19]
  s_waitcnt vmcnt(4)
  buffer_load_dwordx4 v[112:115], v2, s[36:39], s80 offen nt
  s_add_u32 s80, s80, 4096
  s_and_b32 s80, s80, 0x7ffff
  v_and_b32_dpp v24, v69, v4 row_newbcast:12 row_mask:0xf bank_mask:0xf
  v_and_b32_dpp v25, v69, v5 row_newbcast:12 row_mask:0xf bank_mask:0xf
  v_and_b32_dpp v26, v69, v6 row_newbcast:12 row_mask:0xf bank_mask:0xf
  v_and_b32_dpp v27, v69, v7 row_newbcast:12 row_mask:0xf bank_mask:0xf
  s_nop 1
  v_mfma_f32_16x16x32_bf16 v[16:19], v[24:27], v[184:187], v[16:19]
  s_waitcnt vmcnt(4)
  buffer_load_dwordx4 v[116:119], v2, s[36:39], s80 offen nt
  s_add_u32 s80, s80, 4096
  s_and_b32 s80, s80, 0x7ffff
  v_and_b32_dpp v20, v70, v4 row_newbcast:12 row_mask:0xf bank_mask:0xf
  v_and_b32_dpp v21, v70, v5 row_newbcast:12 row_mask:0xf bank_mask:0xf
  v_and_b32_dpp v22, v70, v6 row_newbcast:12 row_mask:0xf bank_mask:0xf
  v_and_b32_dpp v23, v70, v7 row_newbcast:12 row_mask:0xf bank_mask:0xf
  s_nop 1
  v_mfma_f32_16x16x32_bf16 v[16:19], v[20:23], v[192:195], v[16:19]
  s_waitcnt vmcnt(4)
  buffer_load_dwordx4 v[120:123], v2, s[36:39], s80 offen nt
  s_add_u32 s80, s80, 4096
  s_and_b32 s80, s80, 0x7ffff
  v_and_b32_dpp v24, v71, v4 row_newbcast:12 row_mask:0xf bank_mask:0xf
  v_and_b32_dpp v25, v71, v5 row_newbcast:12 row_mask:0xf bank_mask:0xf
  v_and_b32_dpp v26, v71, v6 row_newbcast:12 row_mask:0xf bank_mask:0xf
  v_and_b32_dpp v27, v71, v7 row_newbcast:12 row_mask:0xf bank_mask:0xf
  s_nop 1
  v_mfma_f32_16x16x32_bf16 v[16:19], v[24:27], v[196:199], v[16:19]
  s_waitcnt vmcnt(4)
  buffer_load_dwordx4 v[124:127], v2, s[36:39], s80 offen nt
  s_add_u32 s80, s80, 4096
  s_and_b32 s80, s80, 0x7ffff
  v_and_b32_dpp v20, v72, v4 row_newbcast:0 row_mask:0xf bank_mask:0xf
  v_and_b32_dpp v21, v72, v5 row_newbcast:0 row_mask:0xf bank_mask:0xf
  v_and_b32_dpp v22, v72, v6 row_newbcast:0 row_mask:0xf bank_mask:0xf
  v_and_b32_dpp v23, v72, v7 row_newbcast:0 row_mask:0xf bank_mask:0xf
  s_nop 1
  v_mfma_f32_16x16x32_bf16 v[16:19], v[20:23], v[96:99], v[16:19]
  s_waitcnt vmcnt(4)
  buffer_load_dwordx4 v[128:131], v2, s[36:39], s80 offen nt
  s_add_u32 s80, s80, 4096
  s_and_b32 s80, s80, 0x7ffff
  v_and_b32_dpp v24, v73, v4 row_newbcast:0 row_mask:0xf bank_mask:0xf
  v_and_b32_dpp v25, v73, v5 row_newbcast:0 row_mask:0xf bank_mask:0xf
  v_and_b32_dpp v26, v73, v6 row_newbcast:0 row_mask:0xf bank_mask:0xf
  v_and_b32_dpp v27, v73, v7 row_newbcast:0 row_mask:0xf bank_mask:0xf
  s_nop 1
  v_mfma_f32_16x16x32_bf16 v[16:19], v[24:27], v[100:103], v[16:19]
  s_waitcnt vmcnt(4)
  buffer_load_dwordx4 v[132:135], v2, s[36:39], s80 offen nt
  s_add_u32 s80, s80, 4096
  s_and_b32 s80, s80, 0x7ffff
  v_and_b32_dpp v20, v74, v4 row_newbcast:0 row_mask:0xf bank_mask:0xf
  v_and_b32_dpp v21, v74, v5 row_newbcast:0 row_mask:0xf bank_mask:0xf
  v_and_b32_dpp v22, v74, v6 row_newbcast:0 row_mask:0xf bank_mask:0xf
  v_and_b32_dpp v23, v74, v7 row_newbcast:0 row_mask:0xf bank_mask:0xf
  s_nop 1
  v_mfma_f32_16x16x32_bf16 v[16:19], v[20:23], v[104:107], v[16:19]
  s_waitcnt vmcnt(4)
  buffer_load_dwordx4 v[136:139], v2, s[36:39], s80 offen nt
  s_add_u32 s80, s80, 4096
  s_and_b32 s80, s80, 0x7ffff
  v_and_b32_dpp v24, v75, v4 row_newbcast:0 row_mask:0xf bank_mask:0xf
  v_and_b32_dpp v25, v75, v5 row_newbcast:0 row_mask:0xf bank_mask:0xf
  v_and_b32_dpp v26, v75, v6 row_newbcast:0 row_mask:0xf bank_mask:0xf
  v_and_b32_dpp v27, v75, v7 row_newbcast:0 row_mask:0xf bank_mask:0xf
  s_nop 1
  v_mfma_f32_16x16x32_bf16 v[16:19], v[24:27], v[108:111], v[16:19]
  s_waitcnt vmcnt(4)
  buffer_load_dwordx4 v[140:143], v2, s[36:39], s80 offen nt
  s_add_u32 s80, s80, 4096
  s_and_b32 s80, s80, 0x7ffff
  v_and_b32_dpp v20, v72, v4 row_newbcast:4 row_mask:0xf bank_mask:0xf
  v_and_b32_dpp v21, v72, v5 row_newbcast:4 row_mask:0xf bank_mask:0xf
  v_and_b32_dpp v22, v72, v6 row_newbcast:4 row_mask:0xf bank_mask:0xf
  v_and_b32_dpp v23, v72, v7 row_newbcast:4 row_mask:0xf bank_mask:0xf
  s_nop 1
  v_mfma_f32_16x16x32_bf16 v[16:19], v[20:23], v[112:115], v[16:19]
  s_waitcnt vmcnt(4)
  buffer_load_dwordx4 v[144:147], v2, s[36:39], s80 offen nt
  s_add_u32 s80, s80, 4096
  s_and_b32 s80, s80, 0x7ffff
  v_and_b32_dpp v24, v73, v4 row_newbcast:4 row_mask:0xf bank_mask:0xf
  v_and_b32_dpp v25, v73, v5 row_newbcast:4 row_mask:0xf bank_mask:0xf
  v_and_b32_dpp v26, v73, v6 row_newbcast:4 row_mask:0xf bank_mask:0xf
  v_and_b32_dpp v27, v73, v7 row_newbcast:4 row_mask:0xf bank_mask:0xf
  s_nop 1
  v_mfma_f32_16x16x32_bf16 v[16:19], v[24:27], v[116:119], v[16:19]
  s_waitcnt vmcnt(4)
  buffer_load_dwordx4 v[148:151], v2, s[36:39], s80 offen nt
  s_add_u32 s80, s80, 4096
  s_and_b32 s80, s80, 0x7ffff
  v_and_b32_dpp v20, v74, v4 row_newbcast:4 row_mask:0xf bank_mask:0xf
  v_and_b32_dpp v21, v74, v5 row_newbcast:4 row_mask:0xf bank_mask:0xf
  v_and_b32_dpp v22, v74, v6 row_newbcast:4 row_mask:0xf bank_mask:0xf
  v_and_b32_dpp v23, v74, v7 row_newbcast:4 row_mask:0xf bank_mask:0xf
  s_nop 1
  v_mfma_f32_16x16x32_bf16 v[16:19], v[20:23], v[120:123], v[16:19]
  s_waitcnt vmcnt(4)
  buffer_load_dwordx4 v[176:179], v2, s[36:39], s80 offen nt
  s_add_u32 s80, s80, 4096
  s_and_b32 s80, s80, 0x7ffff
  v_and_b32_dpp v24, v75, v4 row_newbcast:4 row_mask:0xf bank_mask:0xf
  v_and_b32_dpp v25, v75, v5 row_newbcast:4 row_mask:0xf bank_mask:0xf
  v_and_b32_dpp v26, v75, v6 row_newbcast:4 row_mask:0xf bank_mask:0xf
  v_and_b32_dpp v27, v75, v7 row_newbcast:4 row_mask:0xf bank_mask:0xf
  s_nop 1
  v_mfma_f32_16x16x32_bf16 v[16:19], v[24:27], v[124:127], v[16:19]
  s_waitcnt vmcnt(4)
  buffer_load_dwordx4 v[204:207], v2, s[36:39], s80 offen nt
  s_add_u32 s80, s80, 4096
  s_and_b32 s80, s80, 0x7ffff
  v_and_b32_dpp v20, v72, v4 row_newbcast:8 row_mask:0xf bank_mask:0xf
  v_and_b32_dpp v21, v72, v5 row_newbcast:8 row_mask:0xf bank_mask:0xf
  v_and_b32_dpp v22, v72, v6 row_newbcast:8 row_mask:0xf bank_mask:0xf
  v_and_b32_dpp v23, v72, v7 row_newbcast:8 row_mask:0xf bank_mask:0xf
  s_nop 1
  v_mfma_f32_16x16x32_bf16 v[16:19], v[20:23], v[128:131], v[16:19]
  s_waitcnt vmcnt(4)
  buffer_load_dwordx4 v[232:235], v2, s[36:39], s80 offen nt
  s_add_u32 s80, s80, 4096
  s_and_b32 s80, s80, 0x7ffff
  v_and_b32_dpp v24, v73, v4 row_newbcast:8 row_mask:0xf bank_mask:0xf
  v_and_b32_dpp v25, v73, v5 row_newbcast:8 row_mask:0xf bank_mask:0xf
  v_and_b32_dpp v26, v73, v6 row_newbcast:8 row_mask:0xf bank_mask:0xf
  v_and_b32_dpp v27, v73, v7 row_newbcast:8 row_mask:0xf bank_mask:0xf
  s_nop 1
  v_mfma_f32_16x16x32_bf16 v[16:19], v[24:27], v[132:135], v[16:19]
  s_waitcnt vmcnt(4)
  buffer_load_dwordx4 v[156:159], v2, s[36:39], s80 offen nt
  s_add_u32 s80, s80, 4096
  s_and_b32 s80, s80, 0x7ffff
  v_and_b32_dpp v20, v74, v4 row_newbcast:8 row_mask:0xf bank_mask:0xf
  v_and_b32_dpp v21, v74, v5 row_newbcast:8 row_mask:0xf bank_mask:0xf
  v_and_b32_dpp v22, v74, v6 row_newbcast:8 row_mask:0xf bank_mask:0xf
  v_and_b32_dpp v23, v74, v7 row_newbcast:8 row_mask:0xf bank_mask:0xf
  s_nop 1
  v_mfma_f32_16x16x32_bf16 v[16:19], v[20:23], v[136:139], v[16:19]
  s_waitcnt vmcnt(4)
  buffer_load_dwordx4 v[188:191], v2, s[36:39], s80 offen nt
  s_add_u32 s80, s80, 4096
  s_and_b32 s80, s80, 0x7ffff
  v_and_b32_dpp v24, v75, v4 row_newbcast:8 row_mask:0xf bank_mask:0xf
  v_and_b32_dpp v25, v75, v5 row_newbcast:8 row_mask:0xf bank_mask:0xf
  v_and_b32_dpp v26, v75, v6 row_newbcast:8 row_mask:0xf bank_mask:0xf
  v_and_b32_dpp v27, v75, v7 row_newbcast:8 row_mask:0xf bank_mask:0xf
  s_nop 1
  v_mfma_f32_16x16x32_bf16 v[16:19], v[24:27], v[140:143], v[16:19]
  s_waitcnt vmcnt(4)
  buffer_load_dwordx4 v[200:203], v2, s[36:39], s80 offen nt
  s_add_u32 s80, s80, 4096
  s_and_b32 s80, s80, 0x7ffff
  v_and_b32_dpp v20, v72, v4 row_newbcast:12 row_mask:0xf bank_mask:0xf
  v_and_b32_dpp v21, v72, v5 row_newbcast:12 row_mask:0xf bank_mask:0xf
  v_and_b32_dpp v22, v72, v6 row_newbcast:12 row_mask:0xf bank_mask:0xf
  v_and_b32_dpp v23, v72, v7 row_newbcast:12 row_mask:0xf bank_mask:0xf
  s_nop 1
  v_mfma_f32_16x16x32_bf16 v[16:19], v[20:23], v[144:147], v[16:19]
  s_waitcnt vmcnt(4)
  buffer_load_dwordx4 v[208:211], v2, s[36:39], s80 offen nt
  s_add_u32 s80, s80, 4096
  s_and_b32 s80, s80, 0x7ffff
  v_and_b32_dpp v24, v73, v4 row_newbcast:12 row_mask:0xf bank_mask:0xf
  v_and_b32_dpp v25, v73, v5 row_newbcast:12 row_mask:0xf bank_mask:0xf
  v_and_b32_dpp v26, v73, v6 row_newbcast:12 row_mask:0xf bank_mask:0xf
  v_and_b32_dpp v27, v73, v7 row_newbcast:12 row_mask:0xf bank_mask:0xf
  s_nop 1
  v_mfma_f32_16x16x32_bf16 v[16:19], v[24:27], v[148:151], v[16:19]
  s_waitcnt vmcnt(4)
  buffer_load_dwordx4 v[212:215], v2, s[36:39], s80 offen nt
  s_add_u32 s80, s80, 4096
  s_and_b32 s80, s80, 0x7ffff
  v_and_b32_dpp v20, v74, v4 row_newbcast:12 row_mask:0xf bank_mask:0xf
  v_and_b32_dpp v21, v74, v5 row_newbcast:12 row_mask:0xf bank_mask:0xf
  v_and_b32_dpp v22, v74, v6 row_newbcast:12 row_mask:0xf bank_mask:0xf
  v_and_b32_dpp v23, v74, v7 row_newbcast:12 row_mask:0xf bank_mask:0xf
  s_nop 1
  v_mfma_f32_16x16x32_bf16 v[16:19], v[20:23], v[176:179], v[16:19]
  s_waitcnt vmcnt(4)
  buffer_load_dwordx4 v[216:219], v2, s[36:39], s80 offen nt
  s_add_u32 s80, s80, 4096
  s_and_b32 s80, s80, 0x7ffff
  v_and_b32_dpp v24, v75, v4 row_newbcast:12 row_mask:0xf bank_mask:0xf
  v_and_b32_dpp v25, v75, v5 row_newbcast:12 row_mask:0xf bank_mask:0xf
  v_and_b32_dpp v26, v75, v6 row_newbcast:12 row_mask:0xf bank_mask:0xf
  v_and_b32_dpp v27, v75, v7 row_newbcast:12 row_mask:0xf bank_mask:0xf
  s_nop 1
  v_mfma_f32_16x16x32_bf16 v[16:19], v[24:27], v[204:207], v[16:19]
  s_waitcnt vmcnt(4)
  buffer_load_dwordx4 v[220:223], v2, s[36:39], s80 offen nt
  s_add_u32 s80, s80, 4096
  s_and_b32 s80, s80, 0x7ffff
  v_and_b32_dpp v20, v76, v4 row_newbcast:0 row_mask:0xf bank_mask:0xf
  v_and_b32_dpp v21, v76, v5 row_newbcast:0 row_mask:0xf bank_mask:0xf
  v_and_b32_dpp v22, v76, v6 row_newbcast:0 row_mask:0xf bank_mask:0xf
  v_and_b32_dpp v23, v76, v7 row_newbcast:0 row_mask:0xf bank_mask:0xf
  s_nop 1
  v_mfma_f32_16x16x32_bf16 v[16:19], v[20:23], v[232:235], v[16:19]
  s_waitcnt vmcnt(4)
  buffer_load_dwordx4 v[224:227], v2, s[36:39], s80 offen nt
  s_add_u32 s80, s80, 4096
  s_and_b32 s80, s80, 0x7ffff
  v_and_b32_dpp v24, v77, v4 row_newbcast:0 row_mask:0xf bank_mask:0xf
  v_and_b32_dpp v25, v77, v5 row_newbcast:0 row_mask:0xf bank_mask:0xf
  v_and_b32_dpp v26, v77, v6 row_newbcast:0 row_mask:0xf bank_mask:0xf
  v_and_b32_dpp v27, v77, v7 row_newbcast:0 row_mask:0xf bank_mask:0xf
  s_nop 1
  v_mfma_f32_16x16x32_bf16 v[16:19], v[24:27], v[156:159], v[16:19]
  s_waitcnt vmcnt(4)
  buffer_load_dwordx4 v[228:231], v2, s[36:39], s80 offen nt
  s_add_u32 s80, s80, 4096
  s_and_b32 s80, s80, 0x7ffff
  v_and_b32_dpp v20, v78, v4 row_newbcast:0 row_mask:0xf bank_mask:0xf
  v_and_b32_dpp v21, v78, v5 row_newbcast:0 row_mask:0xf bank_mask:0xf
  v_and_b32_dpp v22, v78, v6 row_newbcast:0 row_mask:0xf bank_mask:0xf
  v_and_b32_dpp v23, v78, v7 row_newbcast:0 row_mask:0xf bank_mask:0xf
  s_nop 1
  v_mfma_f32_16x16x32_bf16 v[16:19], v[20:23], v[188:191], v[16:19]
  s_waitcnt vmcnt(4)
  buffer_load_dwordx4 v[236:239], v2, s[36:39], s80 offen nt
  s_add_u32 s80, s80, 4096
  s_and_b32 s80, s80, 0x7ffff
  v_and_b32_dpp v24, v79, v4 row_newbcast:0 row_mask:0xf bank_mask:0xf
  v_and_b32_dpp v25, v79, v5 row_newbcast:0 row_mask:0xf bank_mask:0xf
  v_and_b32_dpp v26, v79, v6 row_newbcast:0 row_mask:0xf bank_mask:0xf
  v_and_b32_dpp v27, v79, v7 row_newbcast:0 row_mask:0xf bank_mask:0xf
  s_nop 1
  v_mfma_f32_16x16x32_bf16 v[16:19], v[24:27], v[200:203], v[16:19]
  s_waitcnt vmcnt(4)
  buffer_load_dwordx4 v[240:243], v2, s[36:39], s80 offen nt
  s_add_u32 s80, s80, 4096
  s_and_b32 s80, s80, 0x7ffff
  v_and_b32_dpp v20, v76, v4 row_newbcast:4 row_mask:0xf bank_mask:0xf
  v_and_b32_dpp v21, v76, v5 row_newbcast:4 row_mask:0xf bank_mask:0xf
  v_and_b32_dpp v22, v76, v6 row_newbcast:4 row_mask:0xf bank_mask:0xf
  v_and_b32_dpp v23, v76, v7 row_newbcast:4 row_mask:0xf bank_mask:0xf
  s_nop 1
  v_mfma_f32_16x16x32_bf16 v[16:19], v[20:23], v[208:211], v[16:19]
  s_waitcnt vmcnt(4)
  buffer_load_dwordx4 v[244:247], v2, s[36:39], s80 offen nt
  s_add_u32 s80, s80, 4096
  s_and_b32 s80, s80, 0x7ffff
  v_and_b32_dpp v24, v77, v4 row_newbcast:4 row_mask:0xf bank_mask:0xf
  v_and_b32_dpp v25, v77, v5 row_newbcast:4 row_mask:0xf bank_mask:0xf
  v_and_b32_dpp v26, v77, v6 row_newbcast:4 row_mask:0xf bank_mask:0xf
  v_and_b32_dpp v27, v77, v7 row_newbcast:4 row_mask:0xf bank_mask:0xf
  s_nop 1
  v_mfma_f32_16x16x32_bf16 v[16:19], v[24:27], v[212:215], v[16:19]
  s_waitcnt vmcnt(4)
  buffer_load_dwordx4 v[248:251], v2, s[36:39], s80 offen nt
  s_add_u32 s80, s80, 4096
  s_and_b32 s80, s80, 0x7ffff
  v_and_b32_dpp v20, v78, v4 row_newbcast:4 row_mask:0xf bank_mask:0xf
  v_and_b32_dpp v21, v78, v5 row_newbcast:4 row_mask:0xf bank_mask:0xf
  v_and_b32_dpp v22, v78, v6 row_newbcast:4 row_mask:0xf bank_mask:0xf
  v_and_b32_dpp v23, v78, v7 row_newbcast:4 row_mask:0xf bank_mask:0xf
  s_nop 1
  v_mfma_f32_16x16x32_bf16 v[16:19], v[20:23], v[216:219], v[16:19]
  s_waitcnt vmcnt(4)
  buffer_load_dwordx4 v[252:255], v2, s[36:39], s80 offen nt
  s_add_u32 s80, s80, 4096
  s_and_b32 s80, s80, 0x7ffff
  v_and_b32_dpp v24, v79, v4 row_newbcast:4 row_mask:0xf bank_mask:0xf
  v_and_b32_dpp v25, v79, v5 row_newbcast:4 row_mask:0xf bank_mask:0xf
  v_and_b32_dpp v26, v79, v6 row_newbcast:4 row_mask:0xf bank_mask:0xf
  v_and_b32_dpp v27, v79, v7 row_newbcast:4 row_mask:0xf bank_mask:0xf
  s_nop 1
  v_mfma_f32_16x16x32_bf16 v[16:19], v[24:27], v[220:223], v[16:19]
  s_waitcnt vmcnt(4)
  buffer_load_dwordx4 v[152:155], v2, s[36:39], s80 offen nt
  s_add_u32 s80, s80, 4096
  s_and_b32 s80, s80, 0x7ffff
  v_and_b32_dpp v20, v76, v4 row_newbcast:8 row_mask:0xf bank_mask:0xf
  v_and_b32_dpp v21, v76, v5 row_newbcast:8 row_mask:0xf bank_mask:0xf
  v_and_b32_dpp v22, v76, v6 row_newbcast:8 row_mask:0xf bank_mask:0xf
  v_and_b32_dpp v23, v76, v7 row_newbcast:8 row_mask:0xf bank_mask:0xf
  s_nop 1
  v_mfma_f32_16x16x32_bf16 v[16:19], v[20:23], v[224:227], v[16:19]
  s_waitcnt vmcnt(4)
  buffer_load_dwordx4 v[160:163], v2, s[36:39], s80 offen nt
  s_add_u32 s80, s80, 4096
  s_and_b32 s80, s80, 0x7ffff
  v_and_b32_dpp v24, v77, v4 row_newbcast:8 row_mask:0xf bank_mask:0xf
  v_and_b32_dpp v25, v77, v5 row_newbcast:8 row_mask:0xf bank_mask:0xf
  v_and_b32_dpp v26, v77, v6 row_newbcast:8 row_mask:0xf bank_mask:0xf
  v_and_b32_dpp v27, v77, v7 row_newbcast:8 row_mask:0xf bank_mask:0xf
  s_nop 1
  v_mfma_f32_16x16x32_bf16 v[16:19], v[24:27], v[228:231], v[16:19]
  s_waitcnt vmcnt(4)
  buffer_load_dwordx4 v[164:167], v2, s[36:39], s80 offen nt
  s_add_u32 s80, s80, 4096
  s_and_b32 s80, s80, 0x7ffff
  v_and_b32_dpp v20, v78, v4 row_newbcast:8 row_mask:0xf bank_mask:0xf
  v_and_b32_dpp v21, v78, v5 row_newbcast:8 row_mask:0xf bank_mask:0xf
  v_and_b32_dpp v22, v78, v6 row_newbcast:8 row_mask:0xf bank_mask:0xf
  v_and_b32_dpp v23, v78, v7 row_newbcast:8 row_mask:0xf bank_mask:0xf
  s_nop 1
  v_mfma_f32_16x16x32_bf16 v[16:19], v[20:23], v[236:239], v[16:19]
  s_waitcnt vmcnt(4)
  buffer_load_dwordx4 v[168:171], v2, s[36:39], s80 offen nt
  s_add_u32 s80, s80, 4096
  s_and_b32 s80, s80, 0x7ffff
  v_and_b32_dpp v24, v79, v4 row_newbcast:8 row_mask:0xf bank_mask:0xf
  v_and_b32_dpp v25, v79, v5 row_newbcast:8 row_mask:0xf bank_mask:0xf
  v_and_b32_dpp v26, v79, v6 row_newbcast:8 row_mask:0xf bank_mask:0xf
  v_and_b32_dpp v27, v79, v7 row_newbcast:8 row_mask:0xf bank_mask:0xf
  s_nop 1
  v_mfma_f32_16x16x32_bf16 v[16:19], v[24:27], v[240:243], v[16:19]
  s_waitcnt vmcnt(4)
  buffer_load_dwordx4 v[172:175], v2, s[36:39], s80 offen nt
  s_add_u32 s80, s80, 4096
  s_and_b32 s80, s80, 0x7ffff
  v_and_b32_dpp v20, v76, v4 row_newbcast:12 row_mask:0xf bank_mask:0xf
  v_and_b32_dpp v21, v76, v5 row_newbcast:12 row_mask:0xf bank_mask:0xf
  v_and_b32_dpp v22, v76, v6 row_newbcast:12 row_mask:0xf bank_mask:0xf
  v_and_b32_dpp v23, v76, v7 row_newbcast:12 row_mask:0xf bank_mask:0xf
  s_nop 1
  v_mfma_f32_16x16x32_bf16 v[16:19], v[20:23], v[244:247], v[16:19]
  s_waitcnt vmcnt(4)
  buffer_load_dwordx4 v[180:183], v2, s[36:39], s80 offen nt
  s_add_u32 s80, s80, 4096
  s_and_b32 s80, s80, 0x7ffff
  v_and_b32_dpp v24, v77, v4 row_newbcast:12 row_mask:0xf bank_mask:0xf
  v_and_b32_dpp v25, v77, v5 row_newbcast:12 row_mask:0xf bank_mask:0xf
  v_and_b32_dpp v26, v77, v6 row_newbcast:12 row_mask:0xf bank_mask:0xf
  v_and_b32_dpp v27, v77, v7 row_newbcast:12 row_mask:0xf bank_mask:0xf
  s_nop 1
  v_mfma_f32_16x16x32_bf16 v[16:19], v[24:27], v[248:251], v[16:19]
  s_waitcnt vmcnt(4)
  buffer_load_dwordx4 v[184:187], v2, s[36:39], s80 offen nt
  s_add_u32 s80, s80, 4096
  s_and_b32 s80, s80, 0x7ffff
  v_and_b32_dpp v20, v78, v4 row_newbcast:12 row_mask:0xf bank_mask:0xf
  v_and_b32_dpp v21, v78, v5 row_newbcast:12 row_mask:0xf bank_mask:0xf
  v_and_b32_dpp v22, v78, v6 row_newbcast:12 row_mask:0xf bank_mask:0xf
  v_and_b32_dpp v23, v78, v7 row_newbcast:12 row_mask:0xf bank_mask:0xf
  s_nop 1
  v_mfma_f32_16x16x32_bf16 v[16:19], v[20:23], v[252:255], v[16:19]
  s_waitcnt vmcnt(4)
  buffer_load_dwordx4 v[192:195], v2, s[36:39], s80 offen nt
  s_add_u32 s80, s80, 4096
  s_and_b32 s80, s80, 0x7ffff
  v_and_b32_dpp v24, v79, v4 row_newbcast:12 row_mask:0xf bank_mask:0xf
  v_and_b32_dpp v25, v79, v5 row_newbcast:12 row_mask:0xf bank_mask:0xf
  v_and_b32_dpp v26, v79, v6 row_newbcast:12 row_mask:0xf bank_mask:0xf
  v_and_b32_dpp v27, v79, v7 row_newbcast:12 row_mask:0xf bank_mask:0xf
  s_nop 1
  v_mfma_f32_16x16x32_bf16 v[16:19], v[24:27], v[152:155], v[16:19]
  s_waitcnt vmcnt(4)
  buffer_load_dwordx4 v[196:199], v2, s[36:39], s80 offen nt
  s_add_u32 s80, s80, 4096
  s_and_b32 s80, s80, 0x7ffff
  v_and_b32_dpp v20, v80, v4 row_newbcast:0 row_mask:0xf bank_mask:0xf
  v_and_b32_dpp v21, v80, v5 row_newbcast:0 row_mask:0xf bank_mask:0xf
  v_and_b32_dpp v22, v80, v6 row_newbcast:0 row_mask:0xf bank_mask:0xf
  v_and_b32_dpp v23, v80, v7 row_newbcast:0 row_mask:0xf bank_mask:0xf
  s_nop 1
  v_mfma_f32_16x16x32_bf16 v[16:19], v[20:23], v[160:163], v[16:19]
  s_waitcnt vmcnt(4)
  buffer_load_dwordx4 v[96:99], v2, s[36:39], s80 offen nt
  s_add_u32 s80, s80, 4096
  s_and_b32 s80, s80, 0x7ffff
  v_and_b32_dpp v24, v81, v4 row_newbcast:0 row_mask:0xf bank_mask:0xf
  v_and_b32_dpp v25, v81, v5 row_newbcast:0 row_mask:0xf bank_mask:0xf
  v_and_b32_dpp v26, v81, v6 row_newbcast:0 row_mask:0xf bank_mask:0xf
  v_and_b32_dpp v27, v81, v7 row_newbcast:0 row_mask:0xf bank_mask:0xf
  s_nop 1
  v_mfma_f32_16x16x32_bf16 v[16:19], v[24:27], v[164:167], v[16:19]
  s_waitcnt vmcnt(4)
  buffer_load_dwordx4 v[100:103], v2, s[36:39], s80 offen nt
  s_add_u32 s80, s80, 4096
  s_and_b32 s80, s80, 0x7ffff
  v_and_b32_dpp v20, v82, v4 row_newbcast:0 row_mask:0xf bank_mask:0xf
  v_and_b32_dpp v21, v82, v5 row_newbcast:0 row_mask:0xf bank_mask:0xf
  v_and_b32_dpp v22, v82, v6 row_newbcast:0 row_mask:0xf bank_mask:0xf
  v_and_b32_dpp v23, v82, v7 row_newbcast:0 row_mask:0xf bank_mask:0xf
  s_nop 1
  v_mfma_f32_16x16x32_bf16 v[16:19], v[20:23], v[168:171], v[16:19]
  s_waitcnt vmcnt(4)
  buffer_load_dwordx4 v[104:107], v2, s[36:39], s80 offen nt
  s_add_u32 s80, s80, 4096
  s_and_b32 s80, s80, 0x7ffff
  v_and_b32_dpp v24, v83, v4 row_newbcast:0 row_mask:0xf bank_mask:0xf
  v_and_b32_dpp v25, v83, v5 row_newbcast:0 row_mask:0xf bank_mask:0xf
  v_and_b32_dpp v26, v83, v6 row_newbcast:0 row_mask:0xf bank_mask:0xf
  v_and_b32_dpp v27, v83, v7 row_newbcast:0 row_mask:0xf bank_mask:0xf
  s_nop 1
  v_mfma_f32_16x16x32_bf16 v[16:19], v[24:27], v[172:175], v[16:19]
  s_waitcnt vmcnt(4)
  buffer_load_dwordx4 v[108:111], v2, s[36:39], s80 offen nt
  s_add_u32 s80, s80, 4096
  s_and_b32 s80, s80, 0x7ffff
  v_and_b32_dpp v20, v80, v4 row_newbcast:4 row_mask:0xf bank_mask:0xf
  v_and_b32_dpp v21, v80, v5 row_newbcast:4 row_mask:0xf bank_mask:0xf
  v_and_b32_dpp v22, v80, v6 row_newbcast:4 row_mask:0xf bank_mask:0xf
  v_and_b32_dpp v23, v80, v7 row_newbcast:4 row_mask:0xf bank_mask:0xf
  s_nop 1
  v_mfma_f32_16x16x32_bf16 v[16:19], v[20:23], v[180:183], v[16:19]
  s_waitcnt vmcnt(4)
  buffer_load_dwordx4 v[112:115], v2, s[36:39], s80 offen nt
  s_add_u32 s80, s80, 4096
  s_and_b32 s80, s80, 0x7ffff
  v_and_b32_dpp v24, v81, v4 row_newbcast:4 row_mask:0xf bank_mask:0xf
  v_and_b32_dpp v25, v81, v5 row_newbcast:4 row_mask:0xf bank_mask:0xf
  v_and_b32_dpp v26, v81, v6 row_newbcast:4 row_mask:0xf bank_mask:0xf
  v_and_b32_dpp v27, v81, v7 row_newbcast:4 row_mask:0xf bank_mask:0xf
  s_nop 1
  v_mfma_f32_16x16x32_bf16 v[16:19], v[24:27], v[184:187], v[16:19]
  s_waitcnt vmcnt(4)
  buffer_load_dwordx4 v[116:119], v2, s[36:39], s80 offen nt
  s_add_u32 s80, s80, 4096
  s_and_b32 s80, s80, 0x7ffff
  v_and_b32_dpp v20, v82, v4 row_newbcast:4 row_mask:0xf bank_mask:0xf
  v_and_b32_dpp v21, v82, v5 row_newbcast:4 row_mask:0xf bank_mask:0xf
  v_and_b32_dpp v22, v82, v6 row_newbcast:4 row_mask:0xf bank_mask:0xf
  v_and_b32_dpp v23, v82, v7 row_newbcast:4 row_mask:0xf bank_mask:0xf
  s_nop 1
  v_mfma_f32_16x16x32_bf16 v[16:19], v[20:23], v[192:195], v[16:19]
  s_waitcnt vmcnt(4)
  buffer_load_dwordx4 v[120:123], v2, s[36:39], s80 offen nt
  s_add_u32 s80, s80, 4096
  s_and_b32 s80, s80, 0x7ffff
  v_and_b32_dpp v24, v83, v4 row_newbcast:4 row_mask:0xf bank_mask:0xf
  v_and_b32_dpp v25, v83, v5 row_newbcast:4 row_mask:0xf bank_mask:0xf
  v_and_b32_dpp v26, v83, v6 row_newbcast:4 row_mask:0xf bank_mask:0xf
  v_and_b32_dpp v27, v83, v7 row_newbcast:4 row_mask:0xf bank_mask:0xf
  s_nop 1
  v_mfma_f32_16x16x32_bf16 v[16:19], v[24:27], v[196:199], v[16:19]
  s_waitcnt vmcnt(4)
  buffer_load_dwordx4 v[124:127], v2, s[36:39], s80 offen nt
  s_add_u32 s80, s80, 4096
  s_and_b32 s80, s80, 0x7ffff
  v_and_b32_dpp v20, v80, v4 row_newbcast:8 row_mask:0xf bank_mask:0xf
  v_and_b32_dpp v21, v80, v5 row_newbcast:8 row_mask:0xf bank_mask:0xf
  v_and_b32_dpp v22, v80, v6 row_newbcast:8 row_mask:0xf bank_mask:0xf
  v_and_b32_dpp v23, v80, v7 row_newbcast:8 row_mask:0xf bank_mask:0xf
  s_nop 1
  v_mfma_f32_16x16x32_bf16 v[16:19], v[20:23], v[96:99], v[16:19]
  s_waitcnt vmcnt(4)
  buffer_load_dwordx4 v[128:131], v2, s[36:39], s80 offen nt
  s_add_u32 s80, s80, 4096
  s_and_b32 s80, s80, 0x7ffff
  v_and_b32_dpp v24, v81, v4 row_newbcast:8 row_mask:0xf bank_mask:0xf
  v_and_b32_dpp v25, v81, v5 row_newbcast:8 row_mask:0xf bank_mask:0xf
  v_and_b32_dpp v26, v81, v6 row_newbcast:8 row_mask:0xf bank_mask:0xf
  v_and_b32_dpp v27, v81, v7 row_newbcast:8 row_mask:0xf bank_mask:0xf
  s_nop 1
  v_mfma_f32_16x16x32_bf16 v[16:19], v[24:27], v[100:103], v[16:19]
  s_waitcnt vmcnt(4)
  buffer_load_dwordx4 v[132:135], v2, s[36:39], s80 offen nt
  s_add_u32 s80, s80, 4096
  s_and_b32 s80, s80, 0x7ffff
  v_and_b32_dpp v20, v82, v4 row_newbcast:8 row_mask:0xf bank_mask:0xf
  v_and_b32_dpp v21, v82, v5 row_newbcast:8 row_mask:0xf bank_mask:0xf
  v_and_b32_dpp v22, v82, v6 row_newbcast:8 row_mask:0xf bank_mask:0xf
  v_and_b32_dpp v23, v82, v7 row_newbcast:8 row_mask:0xf bank_mask:0xf
  s_nop 1
  v_mfma_f32_16x16x32_bf16 v[16:19], v[20:23], v[104:107], v[16:19]
  s_waitcnt vmcnt(4)
  buffer_load_dwordx4 v[136:139], v2, s[36:39], s80 offen nt
  s_add_u32 s80, s80, 4096
  s_and_b32 s80, s80, 0x7ffff
  v_and_b32_dpp v24, v83, v4 row_newbcast:8 row_mask:0xf bank_mask:0xf
  v_and_b32_dpp v25, v83, v5 row_newbcast:8 row_mask:0xf bank_mask:0xf
  v_and_b32_dpp v26, v83, v6 row_newbcast:8 row_mask:0xf bank_mask:0xf
  v_and_b32_dpp v27, v83, v7 row_newbcast:8 row_mask:0xf bank_mask:0xf
  s_nop 1
  v_mfma_f32_16x16x32_bf16 v[16:19], v[24:27], v[108:111], v[16:19]
  s_waitcnt vmcnt(4)
  buffer_load_dwordx4 v[140:143], v2, s[36:39], s80 offen nt
  s_add_u32 s80, s80, 4096
  s_and_b32 s80, s80, 0x7ffff
  v_and_b32_dpp v20, v80, v4 row_newbcast:12 row_mask:0xf bank_mask:0xf
  v_and_b32_dpp v21, v80, v5 row_newbcast:12 row_mask:0xf bank_mask:0xf
  v_and_b32_dpp v22, v80, v6 row_newbcast:12 row_mask:0xf bank_mask:0xf
  v_and_b32_dpp v23, v80, v7 row_newbcast:12 row_mask:0xf bank_mask:0xf
  s_nop 1
  v_mfma_f32_16x16x32_bf16 v[16:19], v[20:23], v[112:115], v[16:19]
  s_waitcnt vmcnt(4)
  buffer_load_dwordx4 v[144:147], v2, s[36:39], s80 offen nt
  s_add_u32 s80, s80, 4096
  s_and_b32 s80, s80, 0x7ffff
  v_and_b32_dpp v24, v81, v4 row_newbcast:12 row_mask:0xf bank_mask:0xf
  v_and_b32_dpp v25, v81, v5 row_newbcast:12 row_mask:0xf bank_mask:0xf
  v_and_b32_dpp v26, v81, v6 row_newbcast:12 row_mask:0xf bank_mask:0xf
  v_and_b32_dpp v27, v81, v7 row_newbcast:12 row_mask:0xf bank_mask:0xf
  s_nop 1
  v_mfma_f32_16x16x32_bf16 v[16:19], v[24:27], v[116:119], v[16:19]
  s_waitcnt vmcnt(4)
  buffer_load_dwordx4 v[148:151], v2, s[36:39], s80 offen nt
  s_add_u32 s80, s80, 4096
  s_and_b32 s80, s80, 0x7ffff
  v_and_b32_dpp v20, v82, v4 row_newbcast:12 row_mask:0xf bank_mask:0xf
  v_and_b32_dpp v21, v82, v5 row_newbcast:12 row_mask:0xf bank_mask:0xf
  v_and_b32_dpp v22, v82, v6 row_newbcast:12 row_mask:0xf bank_mask:0xf
  v_and_b32_dpp v23, v82, v7 row_newbcast:12 row_mask:0xf bank_mask:0xf
  s_nop 1
  v_mfma_f32_16x16x32_bf16 v[16:19], v[20:23], v[120:123], v[16:19]
  s_waitcnt vmcnt(4)
  buffer_load_dwordx4 v[176:179], v2, s[36:39], s80 offen nt
  s_add_u32 s80, s80, 4096
  s_and_b32 s80, s80, 0x7ffff
  v_and_b32_dpp v24, v83, v4 row_newbcast:12 row_mask:0xf bank_mask:0xf
  v_and_b32_dpp v25, v83, v5 row_newbcast:12 row_mask:0xf bank_mask:0xf
  v_and_b32_dpp v26, v83, v6 row_newbcast:12 row_mask:0xf bank_mask:0xf
  v_and_b32_dpp v27, v83, v7 row_newbcast:12 row_mask:0xf bank_mask:0xf
  s_nop 1
  v_mfma_f32_16x16x32_bf16 v[16:19], v[24:27], v[124:127], v[16:19]
  s_waitcnt vmcnt(4)
  buffer_load_dwordx4 v[204:207], v2, s[36:39], s80 offen nt
  s_add_u32 s80, s80, 4096
  s_and_b32 s80, s80, 0x7ffff
  v_and_b32_dpp v20, v84, v4 row_newbcast:0 row_mask:0xf bank_mask:0xf
  v_and_b32_dpp v21, v84, v5 row_newbcast:0 row_mask:0xf bank_mask:0xf
  v_and_b32_dpp v22, v84, v6 row_newbcast:0 row_mask:0xf bank_mask:0xf
  v_and_b32_dpp v23, v84, v7 row_newbcast:0 row_mask:0xf bank_mask:0xf
  s_nop 1
  v_mfma_f32_16x16x32_bf16 v[16:19], v[20:23], v[128:131], v[16:19]
  s_waitcnt vmcnt(4)
  buffer_load_dwordx4 v[232:235], v2, s[36:39], s80 offen nt
  s_add_u32 s80, s80, 4096
  s_and_b32 s80, s80, 0x7ffff
  v_and_b32_dpp v24, v85, v4 row_newbcast:0 row_mask:0xf bank_mask:0xf
  v_and_b32_dpp v25, v85, v5 row_newbcast:0 row_mask:0xf bank_mask:0xf
  v_and_b32_dpp v26, v85, v6 row_newbcast:0 row_mask:0xf bank_mask:0xf
  v_and_b32_dpp v27, v85, v7 row_newbcast:0 row_mask:0xf bank_mask:0xf
  s_nop 1
  v_mfma_f32_16x16x32_bf16 v[16:19], v[24:27], v[132:135], v[16:19]
  s_waitcnt vmcnt(4)
  buffer_load_dwordx4 v[156:159], v2, s[36:39], s80 offen nt
  s_add_u32 s80, s80, 4096
  s_and_b32 s80, s80, 0x7ffff
  v_and_b32_dpp v20, v86, v4 row_newbcast:0 row_mask:0xf bank_mask:0xf
  v_and_b32_dpp v21, v86, v5 row_newbcast:0 row_mask:0xf bank_mask:0xf
  v_and_b32_dpp v22, v86, v6 row_newbcast:0 row_mask:0xf bank_mask:0xf
  v_and_b32_dpp v23, v86, v7 row_newbcast:0 row_mask:0xf bank_mask:0xf
  s_nop 1
  v_mfma_f32_16x16x32_bf16 v[16:19], v[20:23], v[136:139], v[16:19]
  s_waitcnt vmcnt(4)
  buffer_load_dwordx4 v[188:191], v2, s[36:39], s80 offen nt
  s_add_u32 s80, s80, 4096
  s_and_b32 s80, s80, 0x7ffff
  v_and_b32_dpp v24, v87, v4 row_newbcast:0 row_mask:0xf bank_mask:0xf
  v_and_b32_dpp v25, v87, v5 row_newbcast:0 row_mask:0xf bank_mask:0xf
  v_and_b32_dpp v26, v87, v6 row_newbcast:0 row_mask:0xf bank_mask:0xf
  v_and_b32_dpp v27, v87, v7 row_newbcast:0 row_mask:0xf bank_mask:0xf
  s_nop 1
  v_mfma_f32_16x16x32_bf16 v[16:19], v[24:27], v[140:143], v[16:19]
  s_waitcnt vmcnt(4)
  buffer_load_dwordx4 v[200:203], v2, s[36:39], s80 offen nt
  s_add_u32 s80, s80, 4096
  s_and_b32 s80, s80, 0x7ffff
  v_and_b32_dpp v20, v84, v4 row_newbcast:4 row_mask:0xf bank_mask:0xf
  v_and_b32_dpp v21, v84, v5 row_newbcast:4 row_mask:0xf bank_mask:0xf
  v_and_b32_dpp v22, v84, v6 row_newbcast:4 row_mask:0xf bank_mask:0xf
  v_and_b32_dpp v23, v84, v7 row_newbcast:4 row_mask:0xf bank_mask:0xf
  s_nop 1
  v_mfma_f32_16x16x32_bf16 v[16:19], v[20:23], v[144:147], v[16:19]
  s_waitcnt vmcnt(4)
  buffer_load_dwordx4 v[208:211], v2, s[36:39], s80 offen nt
  s_add_u32 s80, s80, 4096
  s_and_b32 s80, s80, 0x7ffff
  v_and_b32_dpp v24, v85, v4 row_newbcast:4 row_mask:0xf bank_mask:0xf
  v_and_b32_dpp v25, v85, v5 row_newbcast:4 row_mask:0xf bank_mask:0xf
  v_and_b32_dpp v26, v85, v6 row_newbcast:4 row_mask:0xf bank_mask:0xf
  v_and_b32_dpp v27, v85, v7 row_newbcast:4 row_mask:0xf bank_mask:0xf
  s_nop 1
  v_mfma_f32_16x16x32_bf16 v[16:19], v[24:27], v[148:151], v[16:19]
  s_waitcnt vmcnt(4)
  buffer_load_dwordx4 v[212:215], v2, s[36:39], s80 offen nt
  s_add_u32 s80, s80, 4096
  s_and_b32 s80, s80, 0x7ffff
  v_and_b32_dpp v20, v86, v4 row_newbcast:4 row_mask:0xf bank_mask:0xf
  v_and_b32_dpp v21, v86, v5 row_newbcast:4 row_mask:0xf bank_mask:0xf
  v_and_b32_dpp v22, v86, v6 row_newbcast:4 row_mask:0xf bank_mask:0xf
  v_and_b32_dpp v23, v86, v7 row_newbcast:4 row_mask:0xf bank_mask:0xf
  s_nop 1
  v_mfma_f32_16x16x32_bf16 v[16:19], v[20:23], v[176:179], v[16:19]
  s_waitcnt vmcnt(4)
  buffer_load_dwordx4 v[216:219], v2, s[36:39], s80 offen nt
  s_add_u32 s80, s80, 4096
  s_and_b32 s80, s80, 0x7ffff
  v_and_b32_dpp v24, v87, v4 row_newbcast:4 row_mask:0xf bank_mask:0xf
  v_and_b32_dpp v25, v87, v5 row_newbcast:4 row_mask:0xf bank_mask:0xf
  v_and_b32_dpp v26, v87, v6 row_newbcast:4 row_mask:0xf bank_mask:0xf
  v_and_b32_dpp v27, v87, v7 row_newbcast:4 row_mask:0xf bank_mask:0xf
  s_nop 1
  v_mfma_f32_16x16x32_bf16 v[16:19], v[24:27], v[204:207], v[16:19]
  s_waitcnt vmcnt(4)
  buffer_load_dwordx4 v[220:223], v2, s[36:39], s80 offen nt
  s_add_u32 s80, s80, 4096
  s_and_b32 s80, s80, 0x7ffff
  v_and_b32_dpp v20, v84, v4 row_newbcast:8 row_mask:0xf bank_mask:0xf
  v_and_b32_dpp v21, v84, v5 row_newbcast:8 row_mask:0xf bank_mask:0xf
  v_and_b32_dpp v22, v84, v6 row_newbcast:8 row_mask:0xf bank_mask:0xf
  v_and_b32_dpp v23, v84, v7 row_newbcast:8 row_mask:0xf bank_mask:0xf
  s_nop 1
  v_mfma_f32_16x16x32_bf16 v[16:19], v[20:23], v[232:235], v[16:19]
  buffer_load_dwordx4 v[224:227], v2, s[36:39], s80 offen nt
  s_add_u32 s80, s80, 4096
  s_and_b32 s80, s80, 0x7ffff
  v_and_b32_dpp v24, v85, v4 row_newbcast:8 row_mask:0xf bank_mask:0xf
  v_and_b32_dpp v25, v85, v5 row_newbcast:8 row_mask:0xf bank_mask:0xf
  v_and_b32_dpp v26, v85, v6 row_newbcast:8 row_mask:0xf bank_mask:0xf
  v_and_b32_dpp v27, v85, v7 row_newbcast:8 row_mask:0xf bank_mask:0xf
  s_nop 1
  v_mfma_f32_16x16x32_bf16 v[16:19], v[24:27], v[156:159], v[16:19]
  buffer_load_dwordx4 v[228:231], v2, s[36:39], s80 offen nt
  s_add_u32 s80, s80, 4096
  s_and_b32 s80, s80, 0x7ffff
  v_and_b32_dpp v20, v86, v4 row_newbcast:8 row_mask:0xf bank_mask:0xf
  v_and_b32_dpp v21, v86, v5 row_newbcast:8 row_mask:0xf bank_mask:0xf
  v_and_b32_dpp v22, v86, v6 row_newbcast:8 row_mask:0xf bank_mask:0xf
  v_and_b32_dpp v23, v86, v7 row_newbcast:8 row_mask:0xf bank_mask:0xf
  s_nop 1
  v_mfma_f32_16x16x32_bf16 v[16:19], v[20:23], v[188:191], v[16:19]
  buffer_load_dwordx4 v[236:239], v2, s[36:39], s80 offen nt
  s_add_u32 s80, s80, 4096
  s_and_b32 s80, s80, 0x7ffff
  v_and_b32_dpp v24, v87, v4 row_newbcast:8 row_mask:0xf bank_mask:0xf
  v_and_b32_dpp v25, v87, v5 row_newbcast:8 row_mask:0xf bank_mask:0xf
  v_and_b32_dpp v26, v87, v6 row_newbcast:8 row_mask:0xf bank_mask:0xf
  v_and_b32_dpp v27, v87, v7 row_newbcast:8 row_mask:0xf bank_mask:0xf
  s_waitcnt vmcnt(7)
  s_nop 0
  v_mfma_f32_16x16x32_bf16 v[16:19], v[24:27], v[200:203], v[16:19]
  buffer_load_dwordx4 v[240:243], v2, s[36:39], s80 offen nt
  s_add_u32 s80, s80, 4096
  s_and_b32 s80, s80, 0x7ffff
  v_and_b32_dpp v20, v84, v4 row_newbcast:12 row_mask:0xf bank_mask:0xf
  v_and_b32_dpp v21, v84, v5 row_newbcast:12 row_mask:0xf bank_mask:0xf
  v_and_b32_dpp v22, v84, v6 row_newbcast:12 row_mask:0xf bank_mask:0xf
  v_and_b32_dpp v23, v84, v7 row_newbcast:12 row_mask:0xf bank_mask:0xf
  s_waitcnt vmcnt(7)
  s_nop 0
  v_mfma_f32_16x16x32_bf16 v[16:19], v[20:23], v[208:211], v[16:19]
  buffer_load_dwordx4 v[244:247], v2, s[36:39], s80 offen nt
  s_add_u32 s80, s80, 4096
  s_and_b32 s80, s80, 0x7ffff
  v_and_b32_dpp v24, v85, v4 row_newbcast:12 row_mask:0xf bank_mask:0xf
  v_and_b32_dpp v25, v85, v5 row_newbcast:12 row_mask:0xf bank_mask:0xf
  v_and_b32_dpp v26, v85, v6 row_newbcast:12 row_mask:0xf bank_mask:0xf
  v_and_b32_dpp v27, v85, v7 row_newbcast:12 row_mask:0xf bank_mask:0xf
  s_waitcnt vmcnt(7)
  s_nop 0
  v_mfma_f32_16x16x32_bf16 v[16:19], v[24:27], v[212:215], v[16:19]
  buffer_load_dwordx4 v[248:251], v2, s[36:39], s80 offen nt
  s_add_u32 s80, s80, 4096
  s_and_b32 s80, s80, 0x7ffff
  v_and_b32_dpp v20, v86, v4 row_newbcast:12 row_mask:0xf bank_mask:0xf
  v_and_b32_dpp v21, v86, v5 row_newbcast:12 row_mask:0xf bank_mask:0xf
  v_and_b32_dpp v22, v86, v6 row_newbcast:12 row_mask:0xf bank_mask:0xf
  v_and_b32_dpp v23, v86, v7 row_newbcast:12 row_mask:0xf bank_mask:0xf
  s_waitcnt vmcnt(7)
  s_nop 0
  v_mfma_f32_16x16x32_bf16 v[16:19], v[20:23], v[216:219], v[16:19]
  buffer_load_dwordx4 v[252:255], v2, s[36:39], s80 offen nt
  s_add_u32 s80, s80, 4096
  s_and_b32 s80, s80, 0x7ffff
  v_and_b32_dpp v24, v87, v4 row_newbcast:12 row_mask:0xf bank_mask:0xf
  v_and_b32_dpp v25, v87, v5 row_newbcast:12 row_mask:0xf bank_mask:0xf
  v_and_b32_dpp v26, v87, v6 row_newbcast:12 row_mask:0xf bank_mask:0xf
  v_and_b32_dpp v27, v87, v7 row_newbcast:12 row_mask:0xf bank_mask:0xf
  s_waitcnt vmcnt(7)
  s_nop 0
  v_mfma_f32_16x16x32_bf16 v[16:19], v[24:27], v[220:223], v[16:19]
  buffer_load_dwordx4 v[152:155], v2, s[36:39], s80 offen nt
  s_add_u32 s80, s80, 4096
  s_and_b32 s80, s80, 0x7ffff
  v_and_b32_dpp v20, v88, v4 row_newbcast:0 row_mask:0xf bank_mask:0xf
  v_and_b32_dpp v21, v88, v5 row_newbcast:0 row_mask:0xf bank_mask:0xf
  v_and_b32_dpp v22, v88, v6 row_newbcast:0 row_mask:0xf bank_mask:0xf
  v_and_b32_dpp v23, v88, v7 row_newbcast:0 row_mask:0xf bank_mask:0xf
  s_waitcnt vmcnt(7)
  s_nop 0
  v_mfma_f32_16x16x32_bf16 v[16:19], v[20:23], v[224:227], v[16:19]
  buffer_load_dwordx4 v[160:163], v2, s[36:39], s80 offen nt
  s_add_u32 s80, s80, 4096
  s_and_b32 s80, s80, 0x7ffff
  v_and_b32_dpp v24, v89, v4 row_newbcast:0 row_mask:0xf bank_mask:0xf
  v_and_b32_dpp v25, v89, v5 row_newbcast:0 row_mask:0xf bank_mask:0xf
  v_and_b32_dpp v26, v89, v6 row_newbcast:0 row_mask:0xf bank_mask:0xf
  v_and_b32_dpp v27, v89, v7 row_newbcast:0 row_mask:0xf bank_mask:0xf
  s_waitcnt vmcnt(7)
  s_nop 0
  v_mfma_f32_16x16x32_bf16 v[16:19], v[24:27], v[228:231], v[16:19]
  buffer_load_dwordx4 v[164:167], v2, s[36:39], s80 offen nt
  s_add_u32 s80, s80, 4096
  s_and_b32 s80, s80, 0x7ffff
  v_and_b32_dpp v20, v90, v4 row_newbcast:0 row_mask:0xf bank_mask:0xf
  v_and_b32_dpp v21, v90, v5 row_newbcast:0 row_mask:0xf bank_mask:0xf
  v_and_b32_dpp v22, v90, v6 row_newbcast:0 row_mask:0xf bank_mask:0xf
  v_and_b32_dpp v23, v90, v7 row_newbcast:0 row_mask:0xf bank_mask:0xf
  s_waitcnt vmcnt(7)
  s_nop 0
  v_mfma_f32_16x16x32_bf16 v[16:19], v[20:23], v[236:239], v[16:19]
  buffer_load_dwordx4 v[168:171], v2, s[36:39], s80 offen nt
  s_add_u32 s80, s80, 4096
  s_and_b32 s80, s80, 0x7ffff
  v_and_b32_dpp v24, v91, v4 row_newbcast:0 row_mask:0xf bank_mask:0xf
  v_and_b32_dpp v25, v91, v5 row_newbcast:0 row_mask:0xf bank_mask:0xf
  v_and_b32_dpp v26, v91, v6 row_newbcast:0 row_mask:0xf bank_mask:0xf
  v_and_b32_dpp v27, v91, v7 row_newbcast:0 row_mask:0xf bank_mask:0xf
  s_waitcnt vmcnt(7)
  s_nop 0
  v_mfma_f32_16x16x32_bf16 v[16:19], v[24:27], v[240:243], v[16:19]
  buffer_load_dwordx4 v[172:175], v2, s[36:39], s80 offen nt
  s_add_u32 s80, s80, 4096
  s_and_b32 s80, s80, 0x7ffff
  v_and_b32_dpp v20, v88, v4 row_newbcast:4 row_mask:0xf bank_mask:0xf
  v_and_b32_dpp v21, v88, v5 row_newbcast:4 row_mask:0xf bank_mask:0xf
  v_and_b32_dpp v22, v88, v6 row_newbcast:4 row_mask:0xf bank_mask:0xf
  v_and_b32_dpp v23, v88, v7 row_newbcast:4 row_mask:0xf bank_mask:0xf
  s_waitcnt vmcnt(7)
  s_nop 0
  v_mfma_f32_16x16x32_bf16 v[16:19], v[20:23], v[244:247], v[16:19]
  buffer_load_dwordx4 v[180:183], v2, s[36:39], s80 offen nt
  s_add_u32 s80, s80, 4096
  s_and_b32 s80, s80, 0x7ffff
  v_and_b32_dpp v24, v89, v4 row_newbcast:4 row_mask:0xf bank_mask:0xf
  v_and_b32_dpp v25, v89, v5 row_newbcast:4 row_mask:0xf bank_mask:0xf
  v_and_b32_dpp v26, v89, v6 row_newbcast:4 row_mask:0xf bank_mask:0xf
  v_and_b32_dpp v27, v89, v7 row_newbcast:4 row_mask:0xf bank_mask:0xf
  s_waitcnt vmcnt(7)
  s_nop 0
  v_mfma_f32_16x16x32_bf16 v[16:19], v[24:27], v[248:251], v[16:19]
  buffer_load_dwordx4 v[184:187], v2, s[36:39], s80 offen nt
  s_add_u32 s80, s80, 4096
  s_and_b32 s80, s80, 0x7ffff
  v_and_b32_dpp v20, v90, v4 row_newbcast:4 row_mask:0xf bank_mask:0xf
  v_and_b32_dpp v21, v90, v5 row_newbcast:4 row_mask:0xf bank_mask:0xf
  v_and_b32_dpp v22, v90, v6 row_newbcast:4 row_mask:0xf bank_mask:0xf
  v_and_b32_dpp v23, v90, v7 row_newbcast:4 row_mask:0xf bank_mask:0xf
  s_waitcnt vmcnt(7)
  s_nop 0
  v_mfma_f32_16x16x32_bf16 v[16:19], v[20:23], v[252:255], v[16:19]
  buffer_load_dwordx4 v[192:195], v2, s[36:39], s80 offen nt
  s_add_u32 s80, s80, 4096
  s_and_b32 s80, s80, 0x7ffff
  v_and_b32_dpp v24, v91, v4 row_newbcast:4 row_mask:0xf bank_mask:0xf
  v_and_b32_dpp v25, v91, v5 row_newbcast:4 row_mask:0xf bank_mask:0xf
  v_and_b32_dpp v26, v91, v6 row_newbcast:4 row_mask:0xf bank_mask:0xf
  v_and_b32_dpp v27, v91, v7 row_newbcast:4 row_mask:0xf bank_mask:0xf
  s_waitcnt vmcnt(7)
  s_nop 0
  v_mfma_f32_16x16x32_bf16 v[16:19], v[24:27], v[152:155], v[16:19]
  buffer_load_dwordx4 v[196:199], v2, s[36:39], s80 offen nt
  s_add_u32 s80, s80, 4096
  s_and_b32 s80, s80, 0x7ffff
  v_and_b32_dpp v20, v88, v4 row_newbcast:8 row_mask:0xf bank_mask:0xf
  v_and_b32_dpp v21, v88, v5 row_newbcast:8 row_mask:0xf bank_mask:0xf
  v_and_b32_dpp v22, v88, v6 row_newbcast:8 row_mask:0xf bank_mask:0xf
  v_and_b32_dpp v23, v88, v7 row_newbcast:8 row_mask:0xf bank_mask:0xf
  s_waitcnt vmcnt(7)
  s_nop 0
  v_mfma_f32_16x16x32_bf16 v[16:19], v[20:23], v[160:163], v[16:19]
  buffer_load_dwordx4 v[96:99], v2, s[36:39], s80 offen nt
  s_add_u32 s80, s80, 4096
  s_and_b32 s80, s80, 0x7ffff
  v_and_b32_dpp v24, v89, v4 row_newbcast:8 row_mask:0xf bank_mask:0xf
  v_and_b32_dpp v25, v89, v5 row_newbcast:8 row_mask:0xf bank_mask:0xf
  v_and_b32_dpp v26, v89, v6 row_newbcast:8 row_mask:0xf bank_mask:0xf
  v_and_b32_dpp v27, v89, v7 row_newbcast:8 row_mask:0xf bank_mask:0xf
  s_waitcnt vmcnt(7)
  s_nop 0
  v_mfma_f32_16x16x32_bf16 v[16:19], v[24:27], v[164:167], v[16:19]
  buffer_load_dwordx4 v[100:103], v2, s[36:39], s80 offen nt
  s_add_u32 s80, s80, 4096
  s_and_b32 s80, s80, 0x7ffff
  v_and_b32_dpp v20, v90, v4 row_newbcast:8 row_mask:0xf bank_mask:0xf
  v_and_b32_dpp v21, v90, v5 row_newbcast:8 row_mask:0xf bank_mask:0xf
  v_and_b32_dpp v22, v90, v6 row_newbcast:8 row_mask:0xf bank_mask:0xf
  v_and_b32_dpp v23, v90, v7 row_newbcast:8 row_mask:0xf bank_mask:0xf
  s_waitcnt vmcnt(7)
  s_nop 0
  v_mfma_f32_16x16x32_bf16 v[16:19], v[20:23], v[168:171], v[16:19]
  buffer_load_dwordx4 v[104:107], v2, s[36:39], s80 offen nt
  s_add_u32 s80, s80, 4096
  s_and_b32 s80, s80, 0x7ffff
  v_and_b32_dpp v24, v91, v4 row_newbcast:8 row_mask:0xf bank_mask:0xf
  v_and_b32_dpp v25, v91, v5 row_newbcast:8 row_mask:0xf bank_mask:0xf
  v_and_b32_dpp v26, v91, v6 row_newbcast:8 row_mask:0xf bank_mask:0xf
  v_and_b32_dpp v27, v91, v7 row_newbcast:8 row_mask:0xf bank_mask:0xf
  s_waitcnt vmcnt(7)
  s_nop 0
  v_mfma_f32_16x16x32_bf16 v[16:19], v[24:27], v[172:175], v[16:19]
  buffer_load_dwordx4 v[108:111], v2, s[36:39], s80 offen nt
  s_add_u32 s80, s80, 4096
  s_and_b32 s80, s80, 0x7ffff
  v_and_b32_dpp v20, v88, v4 row_newbcast:12 row_mask:0xf bank_mask:0xf
  v_and_b32_dpp v21, v88, v5 row_newbcast:12 row_mask:0xf bank_mask:0xf
  v_and_b32_dpp v22, v88, v6 row_newbcast:12 row_mask:0xf bank_mask:0xf
  v_and_b32_dpp v23, v88, v7 row_newbcast:12 row_mask:0xf bank_mask:0xf
  s_waitcnt vmcnt(7)
  s_nop 0
  v_mfma_f32_16x16x32_bf16 v[16:19], v[20:23], v[180:183], v[16:19]
  buffer_load_dwordx4 v[112:115], v2, s[36:39], s80 offen nt
  s_add_u32 s80, s80, 4096
  s_and_b32 s80, s80, 0x7ffff
  v_and_b32_dpp v24, v89, v4 row_newbcast:12 row_mask:0xf bank_mask:0xf
  v_and_b32_dpp v25, v89, v5 row_newbcast:12 row_mask:0xf bank_mask:0xf
  v_and_b32_dpp v26, v89, v6 row_newbcast:12 row_mask:0xf bank_mask:0xf
  v_and_b32_dpp v27, v89, v7 row_newbcast:12 row_mask:0xf bank_mask:0xf
  s_waitcnt vmcnt(7)
  s_nop 0
  v_mfma_f32_16x16x32_bf16 v[16:19], v[24:27], v[184:187], v[16:19]
  buffer_load_dwordx4 v[116:119], v2, s[36:39], s80 offen nt
  s_add_u32 s80, s80, 4096
  s_and_b32 s80, s80, 0x7ffff
  v_and_b32_dpp v20, v90, v4 row_newbcast:12 row_mask:0xf bank_mask:0xf
  v_and_b32_dpp v21, v90, v5 row_newbcast:12 row_mask:0xf bank_mask:0xf
  v_and_b32_dpp v22, v90, v6 row_newbcast:12 row_mask:0xf bank_mask:0xf
  v_and_b32_dpp v23, v90, v7 row_newbcast:12 row_mask:0xf bank_mask:0xf
  s_waitcnt vmcnt(7)
  s_nop 0
  v_mfma_f32_16x16x32_bf16 v[16:19], v[20:23], v[192:195], v[16:19]
  buffer_load_dwordx4 v[120:123], v2, s[36:39], s80 offen nt
  s_add_u32 s80, s80, 4096
  s_and_b32 s80, s80, 0x7ffff
  v_and_b32_dpp v24, v91, v4 row_newbcast:12 row_mask:0xf bank_mask:0xf
  v_and_b32_dpp v25, v91, v5 row_newbcast:12 row_mask:0xf bank_mask:0xf
  v_and_b32_dpp v26, v91, v6 row_newbcast:12 row_mask:0xf bank_mask:0xf
  v_and_b32_dpp v27, v91, v7 row_newbcast:12 row_mask:0xf bank_mask:0xf
  s_waitcnt vmcnt(7)
  s_nop 0
  v_mfma_f32_16x16x32_bf16 v[16:19], v[24:27], v[196:199], v[16:19]
  buffer_load_dwordx4 v[124:127], v2, s[36:39], s80 offen nt
  s_add_u32 s80, s80, 4096
  s_and_b32 s80, s80, 0x7ffff
  v_and_b32_dpp v20, v92, v4 row_newbcast:0 row_mask:0xf bank_mask:0xf
  v_and_b32_dpp v21, v92, v5 row_newbcast:0 row_mask:0xf bank_mask:0xf
  v_and_b32_dpp v22, v92, v6 row_newbcast:0 row_mask:0xf bank_mask:0xf
  v_and_b32_dpp v23, v92, v7 row_newbcast:0 row_mask:0xf bank_mask:0xf
  s_waitcnt vmcnt(7)
  s_nop 0
  v_mfma_f32_16x16x32_bf16 v[16:19], v[20:23], v[96:99], v[16:19]
  buffer_load_dwordx4 v[128:131], v2, s[36:39], s80 offen nt
  s_add_u32 s80, s80, 4096
  s_and_b32 s80, s80, 0x7ffff
  v_and_b32_dpp v24, v93, v4 row_newbcast:0 row_mask:0xf bank_mask:0xf
  v_and_b32_dpp v25, v93, v5 row_newbcast:0 row_mask:0xf bank_mask:0xf
  v_and_b32_dpp v26, v93, v6 row_newbcast:0 row_mask:0xf bank_mask:0xf
  v_and_b32_dpp v27, v93, v7 row_newbcast:0 row_mask:0xf bank_mask:0xf
  s_waitcnt vmcnt(7)
  s_nop 0
  v_mfma_f32_16x16x32_bf16 v[16:19], v[24:27], v[100:103], v[16:19]
  buffer_load_dwordx4 v[132:135], v2, s[36:39], s80 offen nt
  s_add_u32 s80, s80, 4096
  s_and_b32 s80, s80, 0x7ffff
  v_and_b32_dpp v20, v94, v4 row_newbcast:0 row_mask:0xf bank_mask:0xf
  v_and_b32_dpp v21, v94, v5 row_newbcast:0 row_mask:0xf bank_mask:0xf
  v_and_b32_dpp v22, v94, v6 row_newbcast:0 row_mask:0xf bank_mask:0xf
  v_and_b32_dpp v23, v94, v7 row_newbcast:0 row_mask:0xf bank_mask:0xf
  s_waitcnt vmcnt(7)
  s_nop 0
  v_mfma_f32_16x16x32_bf16 v[16:19], v[20:23], v[104:107], v[16:19]
  buffer_load_dwordx4 v[136:139], v2, s[36:39], s80 offen nt
  s_add_u32 s80, s80, 4096
  s_and_b32 s80, s80, 0x7ffff
  v_and_b32_dpp v24, v95, v4 row_newbcast:0 row_mask:0xf bank_mask:0xf
  v_and_b32_dpp v25, v95, v5 row_newbcast:0 row_mask:0xf bank_mask:0xf
  v_and_b32_dpp v26, v95, v6 row_newbcast:0 row_mask:0xf bank_mask:0xf
  v_and_b32_dpp v27, v95, v7 row_newbcast:0 row_mask:0xf bank_mask:0xf
  s_waitcnt vmcnt(7)
  s_nop 0
  v_mfma_f32_16x16x32_bf16 v[16:19], v[24:27], v[108:111], v[16:19]
  buffer_load_dwordx4 v[140:143], v2, s[36:39], s80 offen nt
  s_add_u32 s80, s80, 4096
  s_and_b32 s80, s80, 0x7ffff
  v_and_b32_dpp v20, v92, v4 row_newbcast:4 row_mask:0xf bank_mask:0xf
  v_and_b32_dpp v21, v92, v5 row_newbcast:4 row_mask:0xf bank_mask:0xf
  v_and_b32_dpp v22, v92, v6 row_newbcast:4 row_mask:0xf bank_mask:0xf
  v_and_b32_dpp v23, v92, v7 row_newbcast:4 row_mask:0xf bank_mask:0xf
  s_waitcnt vmcnt(7)
  s_nop 0
  v_mfma_f32_16x16x32_bf16 v[16:19], v[20:23], v[112:115], v[16:19]
  buffer_load_dwordx4 v[144:147], v2, s[36:39], s80 offen nt
  s_add_u32 s80, s80, 4096
  s_and_b32 s80, s80, 0x7ffff
  v_and_b32_dpp v24, v93, v4 row_newbcast:4 row_mask:0xf bank_mask:0xf
  v_and_b32_dpp v25, v93, v5 row_newbcast:4 row_mask:0xf bank_mask:0xf
  v_and_b32_dpp v26, v93, v6 row_newbcast:4 row_mask:0xf bank_mask:0xf
  v_and_b32_dpp v27, v93, v7 row_newbcast:4 row_mask:0xf bank_mask:0xf
  s_waitcnt vmcnt(7)
  s_nop 0
  v_mfma_f32_16x16x32_bf16 v[16:19], v[24:27], v[116:119], v[16:19]
  buffer_load_dwordx4 v[148:151], v2, s[36:39], s80 offen nt
  s_add_u32 s80, s80, 4096
  s_and_b32 s80, s80, 0x7ffff
  v_and_b32_dpp v20, v94, v4 row_newbcast:4 row_mask:0xf bank_mask:0xf
  v_and_b32_dpp v21, v94, v5 row_newbcast:4 row_mask:0xf bank_mask:0xf
  v_and_b32_dpp v22, v94, v6 row_newbcast:4 row_mask:0xf bank_mask:0xf
  v_and_b32_dpp v23, v94, v7 row_newbcast:4 row_mask:0xf bank_mask:0xf
  s_waitcnt vmcnt(7)
  s_nop 0
  v_mfma_f32_16x16x32_bf16 v[16:19], v[20:23], v[120:123], v[16:19]
  buffer_load_dwordx4 v[176:179], v2, s[36:39], s80 offen nt
  s_add_u32 s80, s80, 4096
  s_and_b32 s80, s80, 0x7ffff
  v_and_b32_dpp v24, v95, v4 row_newbcast:4 row_mask:0xf bank_mask:0xf
  v_and_b32_dpp v25, v95, v5 row_newbcast:4 row_mask:0xf bank_mask:0xf
  v_and_b32_dpp v26, v95, v6 row_newbcast:4 row_mask:0xf bank_mask:0xf
  v_and_b32_dpp v27, v95, v7 row_newbcast:4 row_mask:0xf bank_mask:0xf
  s_waitcnt vmcnt(7)
  s_nop 0
  v_mfma_f32_16x16x32_bf16 v[16:19], v[24:27], v[124:127], v[16:19]
  buffer_load_dwordx4 v[204:207], v2, s[36:39], s80 offen nt
  v_and_b32_dpp v20, v92, v4 row_newbcast:8 row_mask:0xf bank_mask:0xf
  v_and_b32_dpp v21, v92, v5 row_newbcast:8 row_mask:0xf bank_mask:0xf
  v_and_b32_dpp v22, v92, v6 row_newbcast:8 row_mask:0xf bank_mask:0xf
  v_and_b32_dpp v23, v92, v7 row_newbcast:8 row_mask:0xf bank_mask:0xf
  s_waitcnt vmcnt(7)
  s_nop 0
  v_mfma_f32_16x16x32_bf16 v[16:19], v[20:23], v[128:131], v[16:19]
  v_and_b32_dpp v24, v93, v4 row_newbcast:8 row_mask:0xf bank_mask:0xf
  v_and_b32_dpp v25, v93, v5 row_newbcast:8 row_mask:0xf bank_mask:0xf
  v_and_b32_dpp v26, v93, v6 row_newbcast:8 row_mask:0xf bank_mask:0xf
  v_and_b32_dpp v27, v93, v7 row_newbcast:8 row_mask:0xf bank_mask:0xf
  s_waitcnt vmcnt(6)
  s_nop 0
  v_mfma_f32_16x16x32_bf16 v[16:19], v[24:27], v[132:135], v[16:19]
  v_and_b32_dpp v20, v94, v4 row_newbcast:8 row_mask:0xf bank_mask:0xf
  v_and_b32_dpp v21, v94, v5 row_newbcast:8 row_mask:0xf bank_mask:0xf
  v_and_b32_dpp v22, v94, v6 row_newbcast:8 row_mask:0xf bank_mask:0xf
  v_and_b32_dpp v23, v94, v7 row_newbcast:8 row_mask:0xf bank_mask:0xf
  s_waitcnt vmcnt(5)
  s_nop 0
  v_mfma_f32_16x16x32_bf16 v[16:19], v[20:23], v[136:139], v[16:19]
  v_and_b32_dpp v24, v95, v4 row_newbcast:8 row_mask:0xf bank_mask:0xf
  v_and_b32_dpp v25, v95, v5 row_newbcast:8 row_mask:0xf bank_mask:0xf
  v_and_b32_dpp v26, v95, v6 row_newbcast:8 row_mask:0xf bank_mask:0xf
  v_and_b32_dpp v27, v95, v7 row_newbcast:8 row_mask:0xf bank_mask:0xf
  s_waitcnt vmcnt(4)
  s_nop 0
  v_mfma_f32_16x16x32_bf16 v[16:19], v[24:27], v[140:143], v[16:19]
  v_and_b32_dpp v20, v92, v4 row_newbcast:12 row_mask:0xf bank_mask:0xf
  v_and_b32_dpp v21, v92, v5 row_newbcast:12 row_mask:0xf bank_mask:0xf
  v_and_b32_dpp v22, v92, v6 row_newbcast:12 row_mask:0xf bank_mask:0xf
  v_and_b32_dpp v23, v92, v7 row_newbcast:12 row_mask:0xf bank_mask:0xf
  s_waitcnt vmcnt(3)
  s_nop 0
  v_mfma_f32_16x16x32_bf16 v[16:19], v[20:23], v[144:147], v[16:19]
  v_and_b32_dpp v24, v93, v4 row_newbcast:12 row_mask:0xf bank_mask:0xf
  v_and_b32_dpp v25, v93, v5 row_newbcast:12 row_mask:0xf bank_mask:0xf
  v_and_b32_dpp v26, v93, v6 row_newbcast:12 row_mask:0xf bank_mask:0xf
  v_and_b32_dpp v27, v93, v7 row_newbcast:12 row_mask:0xf bank_mask:0xf
  s_waitcnt vmcnt(2)
  s_nop 0
  v_mfma_f32_16x16x32_bf16 v[16:19], v[24:27], v[148:151], v[16:19]
  v_and_b32_dpp v20, v94, v4 row_newbcast:12 row_mask:0xf bank_mask:0xf
  v_and_b32_dpp v21, v94, v5 row_newbcast:12 row_mask:0xf bank_mask:0xf
  v_and_b32_dpp v22, v94, v6 row_newbcast:12 row_mask:0xf bank_mask:0xf
  v_and_b32_dpp v23, v94, v7 row_newbcast:12 row_mask:0xf bank_mask:0xf
  s_waitcnt vmcnt(1)
  s_nop 0
  v_mfma_f32_16x16x32_bf16 v[16:19], v[20:23], v[176:179], v[16:19]
  v_and_b32_dpp v24, v95, v4 row_newbcast:12 row_mask:0xf bank_mask:0xf
  v_and_b32_dpp v25, v95, v5 row_newbcast:12 row_mask:0xf bank_mask:0xf
  v_and_b32_dpp v26, v95, v6 row_newbcast:12 row_mask:0xf bank_mask:0xf
  v_and_b32_dpp v27, v95, v7 row_newbcast:12 row_mask:0xf bank_mask:0xf
  s_waitcnt vmcnt(0)
  s_nop 0
  v_mfma_f32_16x16x32_bf16 v[16:19], v[24:27], v[204:207], v[16:19]
  s_nop 7
  ds_write_b128 v36, v[16:19] offset:24576
  s_waitcnt lgkmcnt(0)
  s_barrier
  s_branch L_fin
L_wt:
  v_mov_b32 v13, 0
  ds_write_b32 v13, v13 offset:28704
  v_and_b32 v11, 1, v14
  v_mul_u32_u24 v11, 1, v11
  v_lshrrev_b32 v2, 1, v14
  v_mul_u32_u24 v2, 2, v2
  v_add_u32 v11, v11, v2
  v_lshlrev_b32 v2, 13, v11
  v_lshl_add_u32 v2, v15, 4, v2
  s_and_b32 s64, s70, 3
  s_mul_i32 s65, s64, 10
  v_add_u32 v44, s65, v15
  v_subrev_u32 v47, 40, v44
  v_min_u32 v44, v47, v44
  v_mul_u32_u24 v44, 4, v44
  v_add_lshl_u32 v44, v44, v11, 1
  v_add_u32 v45, s65, v15
  v_add_u32 v45, 16, v45
  v_subrev_u32 v47, 40, v45
  v_min_u32 v45, v47, v45
  v_mul_u32_u24 v45, 4, v45
  v_add_lshl_u32 v45, v45, v11, 1
  v_add_u32 v46, s65, v15
  v_add_u32 v46, 32, v46
  v_subrev_u32 v47, 40, v46
  v_min_u32 v46, v47, v46
  v_mul_u32_u24 v46, 4, v46
  v_add_lshl_u32 v46, v46, v11, 1
  s_mul_i32 s66, s68, 1310720
  s_lshl_b32 s77, s74, 8
  s_add_u32 s66, s66, s77
  s_add_u32 s67, s66, 1310720
  s_mul_i32 s78, s65, 32768
  s_add_u32 s78, s78, s66
  s_mul_i32 s79, s72, 1280
  s_mul_i32 s77, s68, 320
  s_add_u32 s79, s79, s77
  s_mov_b32 s42, 5242880
  s_mov_b32 s43, 0x20000
  s_mov_b32 s50, 2560
  s_mov_b32 s51, 0x20000
  s_cmp_eq_u32 s75, 1
  s_waitcnt lgkmcnt(0)
  s_cselect_b32 s48, s14, s4
  s_cselect_b32 s49, s15, s5
  s_cselect_b32 s40, s20, s10
  s_cselect_b32 s41, s21, s11
  s_cselect_b32 s44, s22, s12
  s_cselect_b32 s45, s23, s13
  buffer_load_ushort v39, v44, s[48:51], s79 offen
  buffer_load_ushort v40, v45, s[48:51], s79 offen
  buffer_load_ushort v41, v46, s[48:51], s79 offen
  buffer_load_dwordx4 v[96:99], v2, s[40:43], s78 offen
  s_add_u32 s78, s78, 32768
  buffer_load_dwordx4 v[100:103], v2, s[40:43], s78 offen
  s_add_u32 s78, s78, 32768
  s_barrier
  buffer_load_dwordx4 v[104:107], v2, s[40:43], s78 offen
  s_add_u32 s78, s78, 32768
  buffer_load_dwordx4 v[108:111], v2, s[40:43], s78 offen
  s_add_u32 s78, s78, 32768
  buffer_load_dwordx4 v[112:115], v2, s[40:43], s78 offen
  s_add_u32 s78, s78, 32768
  buffer_load_dwordx4 v[116:119], v2, s[40:43], s78 offen
  s_add_u32 s78, s78, 32768
  s_mov_b32 s46, 5242880
  s_mov_b32 s47, 0x20000
  s_mov_b32 s52, s28
  s_mov_b32 s53, s29
  s_mov_b32 s54, 675840
  s_mov_b32 s55, 0x20000
  s_mov_b32 s56, s24
  s_mov_b32 s57, s25
  s_mov_b32 s58, 5120
  s_mov_b32 s59, 0x20000
  s_mov_b32 s60, s26
  s_mov_b32 s61, s27
  s_mov_b32 s62, 256
  s_mov_b32 s63, 0x20000
  s_lshl_b32 s81, s75, 1
  s_add_u32 s81, s81, s72
  s_lshl_b32 s82, s74, 1
  s_add_u32 s82, s82, s73
  s_mul_i32 s77, s81, 168960
  s_lshl_b32 s83, s82, 7
  s_add_u32 s83, s77, s83
  v_and_b32 v0, 255, v0
  s_mov_b32 s95, 8448
  v_lshrrev_b32 v42, 3, v0
  v_mul_lo_u32 v42, v42, s95
  v_and_b32 v43, 7, v0
  v_lshl_add_u32 v42, v43, 4, v42
  v_add_u32 v42, s83, v42
  v_mov_b32 v44, 0x7ffffff0
  v_cmp_gt_u32 vcc, 160, v0
  s_nop 1
  v_cndmask_b32 v42, v44, v42, vcc
  s_lshl_b32 s83, s82, 2
  s_add_u32 s83, s83, s77
  s_add_u32 s83, s83, 8192
  v_subrev_u32 v45, 160, v0
  v_mul_lo_u32 v43, v45, s95
  v_add_u32 v43, s83, v43
  v_cmp_gt_u32 vcc, 20, v45
  s_nop 1
  v_cndmask_b32 v43, v44, v43, vcc
  v_mov_b32 v12, 0xffff
  v_mov_b32 v13, 0xffff0000
  v_cmp_eq_u32 vcc, 0, v15
  s_nop 1
  v_cndmask_b32 v4, 0, v12, vcc
  v_cmp_eq_u32 vcc, 1, v15
  s_nop 1
  v_cndmask_b32 v4, v4, v13, vcc
  v_cmp_eq_u32 vcc, 2, v15
  s_nop 1
  v_cndmask_b32 v5, 0, v12, vcc
  v_cmp_eq_u32 vcc, 3, v15
  s_nop 1
  v_cndmask_b32 v5, v5, v13, vcc
  v_cmp_eq_u32 vcc, 4, v15
  s_nop 1
  v_cndmask_b32 v6, 0, v12, vcc
  v_cmp_eq_u32 vcc, 5, v15
  s_nop 1
  v_cndmask_b32 v6, v6, v13, vcc
  v_cmp_eq_u32 vcc, 6, v15
  s_nop 1
  v_cndmask_b32 v7, 0, v12, vcc
  v_cmp_eq_u32 vcc, 7, v15
  s_nop 1
  v_cndmask_b32 v7, v7, v13, vcc
  v_lshrrev_b32 v12, 1, v14
  v_lshlrev_b32 v12, 9, v12
  v_lshl_add_u32 v12, v15, 5, v12
  v_and_b32 v13, 1, v14
  v_lshl_add_u32 v37, v13, 4, v12
  s_lshl_b32 s77, s68, 10
  v_add_u32 v36, s77, v37
  v_mul_u32_u24 v3, 1280, v14
  v_lshl_add_u32 v3, v15, 4, v3
  s_lshl_b32 s88, s74, 7
  s_lshl_b32 s77, s68, 5
  s_add_u32 s88, s88, s77
  s_mul_i32 s88, s88, 1280
  s_add_u32 s89, s88, 40960
  s_mul_i32 s83, s64, 10240
  s_add_u32 s83, s83, s88
  s_lshr_b32 s90, s2, 1
  s_mul_i32 s91, s90, 3277
  s_lshr_b32 s91, s91, 16
  s_mul_i32 s92, s91, 20
  s_sub_u32 s92, s90, s92
  buffer_load_dwordx4 v[120:123], v2, s[40:43], s78 offen
  s_add_u32 s78, s78, 32768
  buffer_load_dwordx4 v[124:127], v2, s[40:43], s78 offen
  s_add_u32 s78, s78, 32768
  s_waitcnt vmcnt(8)
  v_lshl_or_b32 v39, v39, 16, v39
  v_lshl_or_b32 v40, v40, 16, v40
  v_lshl_or_b32 v41, v41, 16, v41
  v_and_b32_dpp v20, v39, v4 row_newbcast:0 row_mask:0xf bank_mask:0xf
  v_and_b32_dpp v21, v39, v5 row_newbcast:0 row_mask:0xf bank_mask:0xf
  v_and_b32_dpp v22, v39, v6 row_newbcast:0 row_mask:0xf bank_mask:0xf
  v_and_b32_dpp v23, v39, v7 row_newbcast:0 row_mask:0xf bank_mask:0xf
  s_waitcnt vmcnt(7)
  s_nop 0
  v_mfma_f32_16x16x32_bf16 v[16:19], v[20:23], v[96:99], 0
  buffer_load_dwordx4 v[128:131], v2, s[40:43], s78 offen
  s_add_u32 s78, s78, 32768
  v_and_b32_dpp v24, v39, v4 row_newbcast:1 row_mask:0xf bank_mask:0xf
  v_and_b32_dpp v25, v39, v5 row_newbcast:1 row_mask:0xf bank_mask:0xf
  v_and_b32_dpp v26, v39, v6 row_newbcast:1 row_mask:0xf bank_mask:0xf
  v_and_b32_dpp v27, v39, v7 row_newbcast:1 row_mask:0xf bank_mask:0xf
  s_waitcnt vmcnt(7)
  s_nop 0
  v_mfma_f32_16x16x32_bf16 v[16:19], v[24:27], v[100:103], v[16:19]
  buffer_load_dwordx4 v[132:135], v2, s[40:43], s78 offen
  s_add_u32 s78, s78, 32768
  s_cmp_ge_u32 s78, s67
  s_cselect_b32 s78, s66, s78
  v_and_b32_dpp v20, v39, v4 row_newbcast:2 row_mask:0xf bank_mask:0xf
  v_and_b32_dpp v21, v39, v5 row_newbcast:2 row_mask:0xf bank_mask:0xf
  v_and_b32_dpp v22, v39, v6 row_newbcast:2 row_mask:0xf bank_mask:0xf
  v_and_b32_dpp v23, v39, v7 row_newbcast:2 row_mask:0xf bank_mask:0xf
  s_waitcnt vmcnt(7)
  s_nop 0
  v_mfma_f32_16x16x32_bf16 v[16:19], v[20:23], v[104:107], v[16:19]
  buffer_load_dwordx4 v[136:139], v2, s[40:43], s78 offen
  s_add_u32 s78, s78, 32768
  v_and_b32_dpp v24, v39, v4 row_newbcast:3 row_mask:0xf bank_mask:0xf
  v_and_b32_dpp v25, v39, v5 row_newbcast:3 row_mask:0xf bank_mask:0xf
  v_and_b32_dpp v26, v39, v6 row_newbcast:3 row_mask:0xf bank_mask:0xf
  v_and_b32_dpp v27, v39, v7 row_newbcast:3 row_mask:0xf bank_mask:0xf
  s_waitcnt vmcnt(7)
  s_nop 0
  v_mfma_f32_16x16x32_bf16 v[16:19], v[24:27], v[108:111], v[16:19]
  buffer_load_dwordx4 v[140:143], v2, s[40:43], s78 offen
  s_add_u32 s78, s78, 32768
  v_and_b32_dpp v20, v39, v4 row_newbcast:4 row_mask:0xf bank_mask:0xf
  v_and_b32_dpp v21, v39, v5 row_newbcast:4 row_mask:0xf bank_mask:0xf
  v_and_b32_dpp v22, v39, v6 row_newbcast:4 row_mask:0xf bank_mask:0xf
  v_and_b32_dpp v23, v39, v7 row_newbcast:4 row_mask:0xf bank_mask:0xf
  s_waitcnt vmcnt(7)
  s_nop 0
  v_mfma_f32_16x16x32_bf16 v[16:19], v[20:23], v[112:115], v[16:19]
  buffer_load_dwordx4 v[144:147], v2, s[40:43], s78 offen
  s_add_u32 s78, s78, 32768
  v_and_b32_dpp v24, v39, v4 row_newbcast:5 row_mask:0xf bank_mask:0xf
  v_and_b32_dpp v25, v39, v5 row_newbcast:5 row_mask:0xf bank_mask:0xf
  v_and_b32_dpp v26, v39, v6 row_newbcast:5 row_mask:0xf bank_mask:0xf
  v_and_b32_dpp v27, v39, v7 row_newbcast:5 row_mask:0xf bank_mask:0xf
  s_waitcnt vmcnt(7)
  s_nop 0
  v_mfma_f32_16x16x32_bf16 v[16:19], v[24:27], v[116:119], v[16:19]
  buffer_load_dwordx4 v[148:151], v2, s[40:43], s78 offen
  s_add_u32 s78, s78, 32768
  v_and_b32_dpp v20, v39, v4 row_newbcast:6 row_mask:0xf bank_mask:0xf
  v_and_b32_dpp v21, v39, v5 row_newbcast:6 row_mask:0xf bank_mask:0xf
  v_and_b32_dpp v22, v39, v6 row_newbcast:6 row_mask:0xf bank_mask:0xf
  v_and_b32_dpp v23, v39, v7 row_newbcast:6 row_mask:0xf bank_mask:0xf
  s_waitcnt vmcnt(7)
  s_nop 0
  v_mfma_f32_16x16x32_bf16 v[16:19], v[20:23], v[120:123], v[16:19]
  buffer_load_dwordx4 v[152:155], v2, s[40:43], s78 offen
  s_add_u32 s78, s78, 32768
  v_and_b32_dpp v24, v39, v4 row_newbcast:7 row_mask:0xf bank_mask:0xf
  v_and_b32_dpp v25, v39, v5 row_newbcast:7 row_mask:0xf bank_mask:0xf
  v_and_b32_dpp v26, v39, v6 row_newbcast:7 row_mask:0xf bank_mask:0xf
  v_and_b32_dpp v27, v39, v7 row_newbcast:7 row_mask:0xf bank_mask:0xf
  s_waitcnt vmcnt(7)
  s_nop 0
  v_mfma_f32_16x16x32_bf16 v[16:19], v[24:27], v[124:127], v[16:19]
  buffer_load_dwordx4 v[156:159], v2, s[40:43], s78 offen
  s_add_u32 s78, s78, 32768
  v_and_b32_dpp v20, v39, v4 row_newbcast:8 row_mask:0xf bank_mask:0xf
  v_and_b32_dpp v21, v39, v5 row_newbcast:8 row_mask:0xf bank_mask:0xf
  v_and_b32_dpp v22, v39, v6 row_newbcast:8 row_mask:0xf bank_mask:0xf
  v_and_b32_dpp v23, v39, v7 row_newbcast:8 row_mask:0xf bank_mask:0xf
  s_waitcnt vmcnt(7)
  s_nop 0
  v_mfma_f32_16x16x32_bf16 v[16:19], v[20:23], v[128:131], v[16:19]
  buffer_load_dwordx4 v[160:163], v2, s[40:43], s78 offen
  s_add_u32 s78, s78, 32768
  v_and_b32_dpp v24, v39, v4 row_newbcast:9 row_mask:0xf bank_mask:0xf
  v_and_b32_dpp v25, v39, v5 row_newbcast:9 row_mask:0xf bank_mask:0xf
  v_and_b32_dpp v26, v39, v6 row_newbcast:9 row_mask:0xf bank_mask:0xf
  v_and_b32_dpp v27, v39, v7 row_newbcast:9 row_mask:0xf bank_mask:0xf
  s_waitcnt vmcnt(7)
  s_nop 0
  v_mfma_f32_16x16x32_bf16 v[16:19], v[24:27], v[132:135], v[16:19]
  buffer_load_dwordx4 v[164:167], v2, s[40:43], s78 offen
  s_add_u32 s78, s78, 32768
  v_and_b32_dpp v20, v39, v4 row_newbcast:10 row_mask:0xf bank_mask:0xf
  v_and_b32_dpp v21, v39, v5 row_newbcast:10 row_mask:0xf bank_mask:0xf
  v_and_b32_dpp v22, v39, v6 row_newbcast:10 row_mask:0xf bank_mask:0xf
  v_and_b32_dpp v23, v39, v7 row_newbcast:10 row_mask:0xf bank_mask:0xf
  s_waitcnt vmcnt(7)
  s_nop 0
  v_mfma_f32_16x16x32_bf16 v[16:19], v[20:23], v[136:139], v[16:19]
  buffer_load_dwordx4 v[168:171], v2, s[40:43], s78 offen
  s_add_u32 s78, s78, 32768
  v_and_b32_dpp v24, v39, v4 row_newbcast:11 row_mask:0xf bank_mask:0xf
  v_and_b32_dpp v25, v39, v5 row_newbcast:11 row_mask:0xf bank_mask:0xf
  v_and_b32_dpp v26, v39, v6 row_newbcast:11 row_mask:0xf bank_mask:0xf
  v_and_b32_dpp v27, v39, v7 row_newbcast:11 row_mask:0xf bank_mask:0xf
  s_waitcnt vmcnt(7)
  s_nop 0
  v_mfma_f32_16x16x32_bf16 v[16:19], v[24:27], v[140:143], v[16:19]
  buffer_load_dwordx4 v[172:175], v2, s[40:43], s78 offen
  s_add_u32 s78, s78, 32768
  s_cmp_ge_u32 s78, s67
  s_cselect_b32 s78, s66, s78
  v_and_b32_dpp v20, v39, v4 row_newbcast:12 row_mask:0xf bank_mask:0xf
  v_and_b32_dpp v21, v39, v5 row_newbcast:12 row_mask:0xf bank_mask:0xf
  v_and_b32_dpp v22, v39, v6 row_newbcast:12 row_mask:0xf bank_mask:0xf
  v_and_b32_dpp v23, v39, v7 row_newbcast:12 row_mask:0xf bank_mask:0xf
  s_waitcnt vmcnt(7)
  s_nop 0
  v_mfma_f32_16x16x32_bf16 v[16:19], v[20:23], v[144:147], v[16:19]
  buffer_load_dwordx4 v[176:179], v2, s[40:43], s78 offen
  s_add_u32 s78, s78, 32768
  v_and_b32_dpp v24, v39, v4 row_newbcast:13 row_mask:0xf bank_mask:0xf
  v_and_b32_dpp v25, v39, v5 row_newbcast:13 row_mask:0xf bank_mask:0xf
  v_and_b32_dpp v26, v39, v6 row_newbcast:13 row_mask:0xf bank_mask:0xf
  v_and_b32_dpp v27, v39, v7 row_newbcast:13 row_mask:0xf bank_mask:0xf
  s_waitcnt vmcnt(7)
  s_nop 0
  v_mfma_f32_16x16x32_bf16 v[16:19], v[24:27], v[148:151], v[16:19]
  buffer_load_dwordx4 v[180:183], v2, s[40:43], s78 offen
  s_add_u32 s78, s78, 32768
  v_and_b32_dpp v20, v39, v4 row_newbcast:14 row_mask:0xf bank_mask:0xf
  v_and_b32_dpp v21, v39, v5 row_newbcast:14 row_mask:0xf bank_mask:0xf
  v_and_b32_dpp v22, v39, v6 row_newbcast:14 row_mask:0xf bank_mask:0xf
  v_and_b32_dpp v23, v39, v7 row_newbcast:14 row_mask:0xf bank_mask:0xf
  s_waitcnt vmcnt(7)
  s_nop 0
  v_mfma_f32_16x16x32_bf16 v[16:19], v[20:23], v[152:155], v[16:19]
  buffer_load_dwordx4 v[184:187], v2, s[40:43], s78 offen
  s_add_u32 s78, s78, 32768
  v_and_b32_dpp v24, v39, v4 row_newbcast:15 row_mask:0xf bank_mask:0xf
  v_and_b32_dpp v25, v39, v5 row_newbcast:15 row_mask:0xf bank_mask:0xf
  v_and_b32_dpp v26, v39, v6 row_newbcast:15 row_mask:0xf bank_mask:0xf
  v_and_b32_dpp v27, v39, v7 row_newbcast:15 row_mask:0xf bank_mask:0xf
  s_waitcnt vmcnt(7)
  s_nop 0
  v_mfma_f32_16x16x32_bf16 v[16:19], v[24:27], v[156:159], v[16:19]
  buffer_load_dwordx4 v[188:191], v2, s[40:43], s78 offen
  s_add_u32 s78, s78, 32768
  v_and_b32_dpp v20, v40, v4 row_newbcast:0 row_mask:0xf bank_mask:0xf
  v_and_b32_dpp v21, v40, v5 row_newbcast:0 row_mask:0xf bank_mask:0xf
  v_and_b32_dpp v22, v40, v6 row_newbcast:0 row_mask:0xf bank_mask:0xf
  v_and_b32_dpp v23, v40, v7 row_newbcast:0 row_mask:0xf bank_mask:0xf
  s_waitcnt vmcnt(7)
  s_nop 0
  v_mfma_f32_16x16x32_bf16 v[16:19], v[20:23], v[160:163], v[16:19]
  buffer_load_dwordx4 v[192:195], v2, s[40:43], s78 offen
  s_add_u32 s78, s78, 32768
  v_and_b32_dpp v24, v40, v4 row_newbcast:1 row_mask:0xf bank_mask:0xf
  v_and_b32_dpp v25, v40, v5 row_newbcast:1 row_mask:0xf bank_mask:0xf
  v_and_b32_dpp v26, v40, v6 row_newbcast:1 row_mask:0xf bank_mask:0xf
  v_and_b32_dpp v27, v40, v7 row_newbcast:1 row_mask:0xf bank_mask:0xf
  s_waitcnt vmcnt(7)
  s_nop 0
  v_mfma_f32_16x16x32_bf16 v[16:19], v[24:27], v[164:167], v[16:19]
  buffer_load_dwordx4 v[196:199], v2, s[40:43], s78 offen
  s_add_u32 s78, s78, 32768
  v_and_b32_dpp v20, v40, v4 row_newbcast:2 row_mask:0xf bank_mask:0xf
  v_and_b32_dpp v21, v40, v5 row_newbcast:2 row_mask:0xf bank_mask:0xf
  v_and_b32_dpp v22, v40, v6 row_newbcast:2 row_mask:0xf bank_mask:0xf
  v_and_b32_dpp v23, v40, v7 row_newbcast:2 row_mask:0xf bank_mask:0xf
  s_waitcnt vmcnt(7)
  s_nop 0
  v_mfma_f32_16x16x32_bf16 v[16:19], v[20:23], v[168:171], v[16:19]
  buffer_load_dwordx4 v[200:203], v2, s[40:43], s78 offen
  s_add_u32 s78, s78, 32768
  v_and_b32_dpp v24, v40, v4 row_newbcast:3 row_mask:0xf bank_mask:0xf
  v_and_b32_dpp v25, v40, v5 row_newbcast:3 row_mask:0xf bank_mask:0xf
  v_and_b32_dpp v26, v40, v6 row_newbcast:3 row_mask:0xf bank_mask:0xf
  v_and_b32_dpp v27, v40, v7 row_newbcast:3 row_mask:0xf bank_mask:0xf
  s_waitcnt vmcnt(7)
  s_nop 0
  v_mfma_f32_16x16x32_bf16 v[16:19], v[24:27], v[172:175], v[16:19]
  buffer_load_dwordx4 v[204:207], v2, s[40:43], s78 offen
  s_add_u32 s78, s78, 32768
  v_and_b32_dpp v20, v40, v4 row_newbcast:4 row_mask:0xf bank_mask:0xf
  v_and_b32_dpp v21, v40, v5 row_newbcast:4 row_mask:0xf bank_mask:0xf
  v_and_b32_dpp v22, v40, v6 row_newbcast:4 row_mask:0xf bank_mask:0xf
  v_and_b32_dpp v23, v40, v7 row_newbcast:4 row_mask:0xf bank_mask:0xf
  s_waitcnt vmcnt(7)
  s_nop 0
  v_mfma_f32_16x16x32_bf16 v[16:19], v[20:23], v[176:179], v[16:19]
  buffer_load_dwordx4 v[208:211], v2, s[40:43], s78 offen
  s_add_u32 s78, s78, 32768
  v_and_b32_dpp v24, v40, v4 row_newbcast:5 row_mask:0xf bank_mask:0xf
  v_and_b32_dpp v25, v40, v5 row_newbcast:5 row_mask:0xf bank_mask:0xf
  v_and_b32_dpp v26, v40, v6 row_newbcast:5 row_mask:0xf bank_mask:0xf
  v_and_b32_dpp v27, v40, v7 row_newbcast:5 row_mask:0xf bank_mask:0xf
  s_waitcnt vmcnt(7)
  s_nop 0
  v_mfma_f32_16x16x32_bf16 v[16:19], v[24:27], v[180:183], v[16:19]
  buffer_load_dwordx4 v[212:215], v2, s[40:43], s78 offen
  s_add_u32 s78, s78, 32768
  s_cmp_ge_u32 s78, s67
  s_cselect_b32 s78, s66, s78
  v_and_b32_dpp v20, v40, v4 row_newbcast:6 row_mask:0xf bank_mask:0xf
  v_and_b32_dpp v21, v40, v5 row_newbcast:6 row_mask:0xf bank_mask:0xf
  v_and_b32_dpp v22, v40, v6 row_newbcast:6 row_mask:0xf bank_mask:0xf
  v_and_b32_dpp v23, v40, v7 row_newbcast:6 row_mask:0xf bank_mask:0xf
  s_waitcnt vmcnt(7)
  s_nop 0
  v_mfma_f32_16x16x32_bf16 v[16:19], v[20:23], v[184:187], v[16:19]
  buffer_load_dwordx4 v[216:219], v2, s[40:43], s78 offen
  s_add_u32 s78, s78, 32768
  v_and_b32_dpp v24, v40, v4 row_newbcast:7 row_mask:0xf bank_mask:0xf
  v_and_b32_dpp v25, v40, v5 row_newbcast:7 row_mask:0xf bank_mask:0xf
  v_and_b32_dpp v26, v40, v6 row_newbcast:7 row_mask:0xf bank_mask:0xf
  v_and_b32_dpp v27, v40, v7 row_newbcast:7 row_mask:0xf bank_mask:0xf
  s_waitcnt vmcnt(7)
  s_nop 0
  v_mfma_f32_16x16x32_bf16 v[16:19], v[24:27], v[188:191], v[16:19]
  buffer_load_dwordx4 v[220:223], v2, s[40:43], s78 offen
  s_add_u32 s78, s78, 32768
  v_and_b32_dpp v20, v40, v4 row_newbcast:8 row_mask:0xf bank_mask:0xf
  v_and_b32_dpp v21, v40, v5 row_newbcast:8 row_mask:0xf bank_mask:0xf
  v_and_b32_dpp v22, v40, v6 row_newbcast:8 row_mask:0xf bank_mask:0xf
  v_and_b32_dpp v23, v40, v7 row_newbcast:8 row_mask:0xf bank_mask:0xf
  s_waitcnt vmcnt(7)
  s_nop 0
  v_mfma_f32_16x16x32_bf16 v[16:19], v[20:23], v[192:195], v[16:19]
  buffer_load_dwordx4 v[224:227], v2, s[40:43], s78 offen
  s_add_u32 s78, s78, 32768
  v_and_b32_dpp v24, v40, v4 row_newbcast:9 row_mask:0xf bank_mask:0xf
  v_and_b32_dpp v25, v40, v5 row_newbcast:9 row_mask:0xf bank_mask:0xf
  v_and_b32_dpp v26, v40, v6 row_newbcast:9 row_mask:0xf bank_mask:0xf
  v_and_b32_dpp v27, v40, v7 row_newbcast:9 row_mask:0xf bank_mask:0xf
  s_waitcnt vmcnt(7)
  s_nop 0
  v_mfma_f32_16x16x32_bf16 v[16:19], v[24:27], v[196:199], v[16:19]
  buffer_load_dwordx4 v[228:231], v2, s[40:43], s78 offen
  s_add_u32 s78, s78, 32768
  v_and_b32_dpp v20, v40, v4 row_newbcast:10 row_mask:0xf bank_mask:0xf
  v_and_b32_dpp v21, v40, v5 row_newbcast:10 row_mask:0xf bank_mask:0xf
  v_and_b32_dpp v22, v40, v6 row_newbcast:10 row_mask:0xf bank_mask:0xf
  v_and_b32_dpp v23, v40, v7 row_newbcast:10 row_mask:0xf bank_mask:0xf
  s_waitcnt vmcnt(7)
  s_nop 0
  v_mfma_f32_16x16x32_bf16 v[16:19], v[20:23], v[200:203], v[16:19]
  buffer_load_dwordx4 v[232:235], v2, s[40:43], s78 offen
  s_add_u32 s78, s78, 32768
  v_and_b32_dpp v24, v40, v4 row_newbcast:11 row_mask:0xf bank_mask:0xf
  v_and_b32_dpp v25, v40, v5 row_newbcast:11 row_mask:0xf bank_mask:0xf
  v_and_b32_dpp v26, v40, v6 row_newbcast:11 row_mask:0xf bank_mask:0xf
  v_and_b32_dpp v27, v40, v7 row_newbcast:11 row_mask:0xf bank_mask:0xf
  s_waitcnt vmcnt(7)
  s_nop 0
  v_mfma_f32_16x16x32_bf16 v[16:19], v[24:27], v[204:207], v[16:19]
  buffer_load_dwordx4 v[236:239], v2, s[40:43], s78 offen
  s_add_u32 s78, s78, 32768
  v_and_b32_dpp v20, v40, v4 row_newbcast:12 row_mask:0xf bank_mask:0xf
  v_and_b32_dpp v21, v40, v5 row_newbcast:12 row_mask:0xf bank_mask:0xf
  v_and_b32_dpp v22, v40, v6 row_newbcast:12 row_mask:0xf bank_mask:0xf
  v_and_b32_dpp v23, v40, v7 row_newbcast:12 row_mask:0xf bank_mask:0xf
  s_waitcnt vmcnt(7)
  s_nop 0
  v_mfma_f32_16x16x32_bf16 v[16:19], v[20:23], v[208:211], v[16:19]
  buffer_load_dwordx4 v[240:243], v2, s[40:43], s78 offen
  s_add_u32 s78, s78, 32768
  v_and_b32_dpp v24, v40, v4 row_newbcast:13 row_mask:0xf bank_mask:0xf
  v_and_b32_dpp v25, v40, v5 row_newbcast:13 row_mask:0xf bank_mask:0xf
  v_and_b32_dpp v26, v40, v6 row_newbcast:13 row_mask:0xf bank_mask:0xf
  v_and_b32_dpp v27, v40, v7 row_newbcast:13 row_mask:0xf bank_mask:0xf
  s_waitcnt vmcnt(7)
  s_nop 0
  v_mfma_f32_16x16x32_bf16 v[16:19], v[24:27], v[212:215], v[16:19]
  buffer_load_dwordx4 v[244:247], v2, s[40:43], s78 offen
  s_add_u32 s78, s78, 32768
  v_and_b32_dpp v20, v40, v4 row_newbcast:14 row_mask:0xf bank_mask:0xf
  v_and_b32_dpp v21, v40, v5 row_newbcast:14 row_mask:0xf bank_mask:0xf
  v_and_b32_dpp v22, v40, v6 row_newbcast:14 row_mask:0xf bank_mask:0xf
  v_and_b32_dpp v23, v40, v7 row_newbcast:14 row_mask:0xf bank_mask:0xf
  s_waitcnt vmcnt(7)
  s_nop 0
  v_mfma_f32_16x16x32_bf16 v[16:19], v[20:23], v[216:219], v[16:19]
  buffer_load_dwordx4 v[248:251], v2, s[40:43], s78 offen
  s_add_u32 s78, s78, 32768
  v_and_b32_dpp v24, v40, v4 row_newbcast:15 row_mask:0xf bank_mask:0xf
  v_and_b32_dpp v25, v40, v5 row_newbcast:15 row_mask:0xf bank_mask:0xf
  v_and_b32_dpp v26, v40, v6 row_newbcast:15 row_mask:0xf bank_mask:0xf
  v_and_b32_dpp v27, v40, v7 row_newbcast:15 row_mask:0xf bank_mask:0xf
  s_waitcnt vmcnt(7)
  s_nop 0
  v_mfma_f32_16x16x32_bf16 v[16:19], v[24:27], v[220:223], v[16:19]
  buffer_load_dwordx4 v[252:255], v2, s[40:43], s78 offen
  s_add_u32 s78, s78, 32768
  v_and_b32_dpp v20, v41, v4 row_newbcast:0 row_mask:0xf bank_mask:0xf
  v_and_b32_dpp v21, v41, v5 row_newbcast:0 row_mask:0xf bank_mask:0xf
  v_and_b32_dpp v22, v41, v6 row_newbcast:0 row_mask:0xf bank_mask:0xf
  v_and_b32_dpp v23, v41, v7 row_newbcast:0 row_mask:0xf bank_mask:0xf
  s_waitcnt vmcnt(7)
  s_nop 0
  v_mfma_f32_16x16x32_bf16 v[16:19], v[20:23], v[224:227], v[16:19]
  v_and_b32_dpp v24, v41, v4 row_newbcast:1 row_mask:0xf bank_mask:0xf
  v_and_b32_dpp v25, v41, v5 row_newbcast:1 row_mask:0xf bank_mask:0xf
  v_and_b32_dpp v26, v41, v6 row_newbcast:1 row_mask:0xf bank_mask:0xf
  v_and_b32_dpp v27, v41, v7 row_newbcast:1 row_mask:0xf bank_mask:0xf
  s_waitcnt vmcnt(6)
  s_nop 0
  v_mfma_f32_16x16x32_bf16 v[16:19], v[24:27], v[228:231], v[16:19]
  v_and_b32_dpp v20, v41, v4 row_newbcast:2 row_mask:0xf bank_mask:0xf
  v_and_b32_dpp v21, v41, v5 row_newbcast:2 row_mask:0xf bank_mask:0xf
  v_and_b32_dpp v22, v41, v6 row_newbcast:2 row_mask:0xf bank_mask:0xf
  v_and_b32_dpp v23, v41, v7 row_newbcast:2 row_mask:0xf bank_mask:0xf
  s_waitcnt vmcnt(5)
  s_nop 0
  v_mfma_f32_16x16x32_bf16 v[16:19], v[20:23], v[232:235], v[16:19]
  v_and_b32_dpp v24, v41, v4 row_newbcast:3 row_mask:0xf bank_mask:0xf
  v_and_b32_dpp v25, v41, v5 row_newbcast:3 row_mask:0xf bank_mask:0xf
  v_and_b32_dpp v26, v41, v6 row_newbcast:3 row_mask:0xf bank_mask:0xf
  v_and_b32_dpp v27, v41, v7 row_newbcast:3 row_mask:0xf bank_mask:0xf
  s_waitcnt vmcnt(4)
  s_nop 0
  v_mfma_f32_16x16x32_bf16 v[16:19], v[24:27], v[236:239], v[16:19]
  v_and_b32_dpp v20, v41, v4 row_newbcast:4 row_mask:0xf bank_mask:0xf
  v_and_b32_dpp v21, v41, v5 row_newbcast:4 row_mask:0xf bank_mask:0xf
  v_and_b32_dpp v22, v41, v6 row_newbcast:4 row_mask:0xf bank_mask:0xf
  v_and_b32_dpp v23, v41, v7 row_newbcast:4 row_mask:0xf bank_mask:0xf
  s_waitcnt vmcnt(3)
  s_nop 0
  v_mfma_f32_16x16x32_bf16 v[16:19], v[20:23], v[240:243], v[16:19]
  v_and_b32_dpp v24, v41, v4 row_newbcast:5 row_mask:0xf bank_mask:0xf
  v_and_b32_dpp v25, v41, v5 row_newbcast:5 row_mask:0xf bank_mask:0xf
  v_and_b32_dpp v26, v41, v6 row_newbcast:5 row_mask:0xf bank_mask:0xf
  v_and_b32_dpp v27, v41, v7 row_newbcast:5 row_mask:0xf bank_mask:0xf
  s_waitcnt vmcnt(2)
  s_nop 0
  v_mfma_f32_16x16x32_bf16 v[16:19], v[24:27], v[244:247], v[16:19]
  v_and_b32_dpp v20, v41, v4 row_newbcast:6 row_mask:0xf bank_mask:0xf
  v_and_b32_dpp v21, v41, v5 row_newbcast:6 row_mask:0xf bank_mask:0xf
  v_and_b32_dpp v22, v41, v6 row_newbcast:6 row_mask:0xf bank_mask:0xf
  v_and_b32_dpp v23, v41, v7 row_newbcast:6 row_mask:0xf bank_mask:0xf
  s_waitcnt vmcnt(1)
  s_nop 0
  v_mfma_f32_16x16x32_bf16 v[16:19], v[20:23], v[248:251], v[16:19]
  v_and_b32_dpp v24, v41, v4 row_newbcast:7 row_mask:0xf bank_mask:0xf
  v_and_b32_dpp v25, v41, v5 row_newbcast:7 row_mask:0xf bank_mask:0xf
  v_and_b32_dpp v26, v41, v6 row_newbcast:7 row_mask:0xf bank_mask:0xf
  v_and_b32_dpp v27, v41, v7 row_newbcast:7 row_mask:0xf bank_mask:0xf
  s_waitcnt vmcnt(0)
  s_nop 0
  v_mfma_f32_16x16x32_bf16 v[16:19], v[24:27], v[252:255], v[16:19]
  s_nop 7
  ds_write_b128 v36, v[16:19] offset:0
  v_mov_b32 v13, 0
  v_mov_b32 v12, 1
  ds_add_u32 v13, v12 offset:28704
  s_mul_i32 s96, s90, 8448
  s_add_u32 s97, s96, 4096
  s_add_u32 s98, s96, 8192
  s_and_b32 s77, s2, 1
  s_lshl_b32 s77, s77, 8
  s_or_b32 s77, s77, s90
  s_xor_b32 s99, s68, 3
  s_lshl_b32 s99, s99, 8
  s_or_b32 s99, s99, s77
  s_cmp_ge_u32 s99, 80
  s_cbranch_scc1 L_noclr
  v_mov_b32 v44, -1
  v_mov_b32 v45, -1
  v_mov_b32 v46, -1
  v_mov_b32 v47, -1
  buffer_store_dwordx4 v[44:47], v1, s[52:55], s96 offen offset:0 sc1
  buffer_store_dwordx4 v[44:47], v1, s[52:55], s96 offen offset:1024 sc1
  buffer_store_dwordx4 v[44:47], v1, s[52:55], s96 offen offset:2048 sc1
  buffer_store_dwordx4 v[44:47], v1, s[52:55], s96 offen offset:3072 sc1
  buffer_store_dwordx4 v[44:47], v1, s[52:55], s97 offen offset:0 sc1
  buffer_store_dwordx4 v[44:47], v1, s[52:55], s97 offen offset:1024 sc1
  buffer_store_dwordx4 v[44:47], v1, s[52:55], s97 offen offset:2048 sc1
  buffer_store_dwordx4 v[44:47], v1, s[52:55], s97 offen offset:3072 sc1
  v_lshrrev_b32 v12, 2, v1
  buffer_store_dword v44, v12, s[52:55], s98 offen sc1
  s_lshl_b32 s77, s91, 5
  s_add_u32 s77, s77, s92
  v_mov_b32 v13, s77
  v_mov_b32 v12, 0x7ffffff0
  v_cmp_eq_u32 vcc, 0, v1
  s_nop 1
  v_cndmask_b32 v13, v12, v13, vcc
  v_mov_b32 v12, 1
  s_waitcnt vmcnt(0)
  buffer_store_byte v12, v13, s[60:63], 0 offen sc1
  s_nop 9
L_noclr:
  buffer_load_dwordx4 v[96:99], v3, s[44:47], s83 offen offset:0
  buffer_load_dwordx4 v[100:103], v3, s[44:47], s83 offen offset:256
  s_waitcnt vmcnt(1)
  buffer_load_dwordx4 v[104:107], v3, s[44:47], s83 offen offset:512
  s_waitcnt vmcnt(1)
  buffer_load_dwordx4 v[108:111], v3, s[44:47], s83 offen offset:768
  s_waitcnt vmcnt(1)
  buffer_load_dwordx4 v[112:115], v3, s[44:47], s83 offen offset:1024
  s_add_u32 s83, s83, 5120
  s_cmp_ge_u32 s83, s89
  s_cselect_b32 s83, s88, s83
  s_waitcnt vmcnt(1)
  buffer_load_dwordx4 v[116:119], v3, s[44:47], s83 offen offset:0
  s_waitcnt vmcnt(1)
  buffer_load_dwordx4 v[120:123], v3, s[44:47], s83 offen offset:256
  s_waitcnt vmcnt(1)
  buffer_load_dwordx4 v[124:127], v3, s[44:47], s83 offen offset:512
  s_waitcnt vmcnt(1)
  buffer_load_dwordx4 v[128:131], v3, s[44:47], s83 offen offset:768
  s_waitcnt vmcnt(1)
  buffer_load_dwordx4 v[132:135], v3, s[44:47], s83 offen offset:1024
  s_add_u32 s83, s83, 5120
  s_cmp_ge_u32 s83, s89
  s_cselect_b32 s83, s88, s83
  s_waitcnt vmcnt(1)
  buffer_load_dwordx4 v[136:139], v3, s[44:47], s83 offen offset:0
  s_waitcnt vmcnt(1)
  buffer_load_dwordx4 v[140:143], v3, s[44:47], s83 offen offset:256
  s_waitcnt vmcnt(1)
  buffer_load_dwordx4 v[144:147], v3, s[44:47], s83 offen offset:512
  s_waitcnt vmcnt(1)
  buffer_load_dwordx4 v[148:151], v3, s[44:47], s83 offen offset:768
  s_waitcnt vmcnt(1)
  buffer_load_dwordx4 v[152:155], v3, s[44:47], s83 offen offset:1024
  s_add_u32 s83, s83, 5120
  s_cmp_ge_u32 s83, s89
  s_cselect_b32 s83, s88, s83
  s_waitcnt vmcnt(1)
  buffer_load_dwordx4 v[156:159], v3, s[44:47], s83 offen offset:0
  s_waitcnt vmcnt(1)
  buffer_load_dwordx4 v[160:163], v3, s[44:47], s83 offen offset:256
  s_waitcnt vmcnt(1)
  buffer_load_dwordx4 v[164:167], v3, s[44:47], s83 offen offset:512
  s_waitcnt vmcnt(1)
  buffer_load_dwordx4 v[168:171], v3, s[44:47], s83 offen offset:768
  s_waitcnt vmcnt(1)
  buffer_load_dwordx4 v[172:175], v3, s[44:47], s83 offen offset:1024
  s_add_u32 s83, s83, 5120
  s_cmp_ge_u32 s83, s89
  s_cselect_b32 s83, s88, s83
  s_waitcnt vmcnt(1)
  buffer_load_dwordx4 v[176:179], v3, s[44:47], s83 offen offset:0
  s_waitcnt vmcnt(1)
  buffer_load_dwordx4 v[180:183], v3, s[44:47], s83 offen offset:256
  s_waitcnt vmcnt(1)
  buffer_load_dwordx4 v[184:187], v3, s[44:47], s83 offen offset:512
  s_waitcnt vmcnt(1)
  buffer_load_dwordx4 v[188:191], v3, s[44:47], s83 offen offset:768
  s_waitcnt vmcnt(1)
  buffer_load_dwordx4 v[192:195], v3, s[44:47], s83 offen offset:1024
  s_add_u32 s83, s83, 5120
  s_cmp_ge_u32 s83, s89
  s_cselect_b32 s83, s88, s83
  s_waitcnt vmcnt(1)
  buffer_load_dwordx4 v[196:199], v3, s[44:47], s83 offen offset:0
  s_waitcnt vmcnt(1)
  buffer_load_dwordx4 v[200:203], v3, s[44:47], s83 offen offset:256
  s_waitcnt vmcnt(1)
  buffer_load_dwordx4 v[204:207], v3, s[44:47], s83 offen offset:512
  s_waitcnt vmcnt(1)
  buffer_load_dwordx4 v[208:211], v3, s[44:47], s83 offen offset:768
  s_waitcnt vmcnt(1)
  buffer_load_dwordx4 v[212:215], v3, s[44:47], s83 offen offset:1024
  s_add_u32 s83, s83, 5120
  s_cmp_ge_u32 s83, s89
  s_cselect_b32 s83, s88, s83
  s_waitcnt vmcnt(1)
  buffer_load_dwordx4 v[216:219], v3, s[44:47], s83 offen offset:0
  s_waitcnt vmcnt(1)
  buffer_load_dwordx4 v[220:223], v3, s[44:47], s83 offen offset:256
  s_waitcnt vmcnt(1)
  buffer_load_dwordx4 v[224:227], v3, s[44:47], s83 offen offset:512
  s_waitcnt vmcnt(1)
  buffer_load_dwordx4 v[228:231], v3, s[44:47], s83 offen offset:768
  s_waitcnt vmcnt(1)
  buffer_load_dwordx4 v[232:235], v3, s[44:47], s83 offen offset:1024
  s_add_u32 s83, s83, 5120
  s_cmp_ge_u32 s83, s89
  s_cselect_b32 s83, s88, s83
  s_waitcnt vmcnt(1)
  buffer_load_dwordx4 v[236:239], v3, s[44:47], s83 offen offset:0
  s_waitcnt vmcnt(1)
  buffer_load_dwordx4 v[240:243], v3, s[44:47], s83 offen offset:256
  s_waitcnt vmcnt(1)
  buffer_load_dwordx4 v[244:247], v3, s[44:47], s83 offen offset:512
  s_waitcnt vmcnt(1)
  buffer_load_dwordx4 v[248:251], v3, s[44:47], s83 offen offset:768
  s_waitcnt vmcnt(1)
  buffer_load_dwordx4 v[252:255], v3, s[44:47], s83 offen offset:1024
  s_add_u32 s83, s83, 5120
  s_cmp_ge_u32 s83, s89
  s_cselect_b32 s83, s88, s83
  s_waitcnt vmcnt(0)
  s_mul_i32 s77, s64, 2
  v_add_u32 v40, s77, v15
  v_and_b32 v40, 7, v40
  v_lshl_add_u32 v40, v40, 2, v14
  v_lshlrev_b32 v40, 2, v40
  s_lshl_b32 s77, s68, 7
  v_add_u32 v40, s77, v40
  s_mul_i32 s77, s68, 5120
  v_add_u32 v41, s77, v37
  v_lshrrev_b32 v38, 5, v0
  v_lshlrev_b32 v38, 10, v38
  v_and_b32 v13, 31, v0
  v_lshl_add_u32 v38, v13, 4, v38
  v_lshrrev_b32 v8, 2, v1
  v_lshrrev_b32 v9, 7, v1
  v_lshlrev_b32 v9, 2, v9
  s_and_b32 s65, s91, 1
  s_mul_i32 s65, s65, 1280
  s_lshr_b32 s77, s91, 1
  s_mul_i32 s77, s77, 640
  s_add_u32 s65, s65, s77
  s_lshl_b32 s77, s92, 5
  s_add_u32 s65, s65, s77
  s_lshl_b32 s65, s65, 1
  v_and_b32 v10, 1, v14
  v_lshlrev_b32 v10, 1, v10
  v_lshrrev_b32 v13, 1, v14
  v_add_u32 v10, v10, v13
  v_lshl_add_u32 v10, v15, 2, v10
  v_lshlrev_b32 v10, 1, v10
  v_mov_b32 v13, 0x7ffffff0
  v_cmp_gt_u32 vcc, 8, v15
  s_nop 1
  v_cndmask_b32 v10, v13, v10, vcc
  s_mov_b32 s94, 0
  s_cmp_lg_u32 s68, 0
  s_cbranch_scc1 L_fok
  v_lshrrev_b32 v12, 2, v1
  v_min_u32 v12, 16, v12
  s_lshl_b32 s77, s81, 5
  v_add_u32 v12, s77, v12
  s_mov_b32 s95, 0x01010101
  s_nop 10
L_fchk:
  buffer_load_dword v39, v12, s[60:63], 0 offen sc1
  s_add_u32 s94, s94, 1
  s_cmp_gt_u32 s94, 0x40000
  s_cbranch_scc1 L_fok
  s_waitcnt vmcnt(0)
  v_cmp_ne_u32 vcc, s95, v39
  s_cbranch_vccz L_fok
  s_sleep 8
  s_branch L_fchk
L_fok:
  v_mov_b32 v12, 0
  s_nop 11
L_mw:
  ds_read_b32 v44, v12 offset:28704
  s_waitcnt lgkmcnt(0)
  v_readfirstlane_b32 s77, v44
  s_cmp_ge_u32 s77, 512
  s_cbranch_scc1 L_mok
  s_sleep 4
  s_branch L_mw
L_mok:
  ds_read_b128 v[48:51], v12 offset:28672
  ds_read_b128 v[52:55], v12 offset:28688
  s_waitcnt lgkmcnt(0)
  v_max3_f32 v45, v48, v50, v52
  v_max_f32 v45, v45, v54
  v_sub_f32 v48, v48, v45
  v_sub_f32 v50, v50, v45
  v_sub_f32 v52, v52, v45
  v_sub_f32 v54, v54, v45
  v_exp_f32 v48, v48
  v_exp_f32 v50, v50
  v_exp_f32 v52, v52
  v_exp_f32 v54, v54
  v_mul_f32 v46, v48, v49
  v_fmac_f32 v46, v50, v51
  v_fmac_f32 v46, v52, v53
  v_fmac_f32 v46, v54, v55
  v_log_f32 v13, v46
  v_rcp_f32 v44, v46
  v_add_f32 v13, v13, v45
  v_min_u32 v47, 0xfffffffe, v13
  v_mul_f32 v28, v44, v48
  v_mul_f32 v29, v44, v50
  v_mul_f32 v30, v44, v52
  v_mul_f32 v31, v44, v54
  s_barrier
  ds_read_b32 v48, v40 offset:24576
  ds_read_b32 v49, v40 offset:25600
  ds_read_b32 v50, v40 offset:26624
  ds_read_b32 v51, v40 offset:27648
  buffer_store_dword v47, v43, s[52:55], 0 offen sc1
  s_waitcnt lgkmcnt(2)
  v_mul_f32 v48, v28, v48
  v_fmac_f32 v48, v29, v49
  s_waitcnt lgkmcnt(0)
  v_fmac_f32 v48, v30, v50
  v_fmac_f32 v48, v31, v51
  v_cvt_pk_bf16_f32 v48, v48, v48
  s_nop 1
  v_and_b32_dpp v20, v48, v4 row_newbcast:0 row_mask:0xf bank_mask:0xf
  v_and_b32_dpp v21, v48, v5 row_newbcast:0 row_mask:0xf bank_mask:0xf
  v_and_b32_dpp v22, v48, v6 row_newbcast:0 row_mask:0xf bank_mask:0xf
  v_and_b32_dpp v23, v48, v7 row_newbcast:0 row_mask:0xf bank_mask:0xf
  s_nop 1
  v_mfma_f32_16x16x32_bf16 v[64:67], v[20:23], v[96:99], 0
  v_and_b32_dpp v24, v48, v4 row_newbcast:1 row_mask:0xf bank_mask:0xf
  v_and_b32_dpp v25, v48, v5 row_newbcast:1 row_mask:0xf bank_mask:0xf
  v_mfma_f32_16x16x32_bf16 v[68:71], v[20:23], v[100:103], 0
  v_and_b32_dpp v26, v48, v6 row_newbcast:1 row_mask:0xf bank_mask:0xf
  v_and_b32_dpp v27, v48, v7 row_newbcast:1 row_mask:0xf bank_mask:0xf
  v_mfma_f32_16x16x32_bf16 v[72:75], v[20:23], v[104:107], 0
  v_mfma_f32_16x16x32_bf16 v[76:79], v[20:23], v[108:111], 0
  v_mfma_f32_16x16x32_bf16 v[80:83], v[20:23], v[112:115], 0
  v_mfma_f32_16x16x32_bf16 v[64:67], v[24:27], v[116:119], v[64:67]
  v_and_b32_dpp v20, v48, v4 row_newbcast:2 row_mask:0xf bank_mask:0xf
  v_and_b32_dpp v21, v48, v5 row_newbcast:2 row_mask:0xf bank_mask:0xf
  v_mfma_f32_16x16x32_bf16 v[68:71], v[24:27], v[120:123], v[68:71]
  v_and_b32_dpp v22, v48, v6 row_newbcast:2 row_mask:0xf bank_mask:0xf
  v_and_b32_dpp v23, v48, v7 row_newbcast:2 row_mask:0xf bank_mask:0xf
  v_mfma_f32_16x16x32_bf16 v[72:75], v[24:27], v[124:127], v[72:75]
  v_mfma_f32_16x16x32_bf16 v[76:79], v[24:27], v[128:131], v[76:79]
  v_mfma_f32_16x16x32_bf16 v[80:83], v[24:27], v[132:135], v[80:83]
  v_mfma_f32_16x16x32_bf16 v[64:67], v[20:23], v[136:139], v[64:67]
  v_and_b32_dpp v24, v48, v4 row_newbcast:3 row_mask:0xf bank_mask:0xf
  v_and_b32_dpp v25, v48, v5 row_newbcast:3 row_mask:0xf bank_mask:0xf
  v_mfma_f32_16x16x32_bf16 v[68:71], v[20:23], v[140:143], v[68:71]
  v_and_b32_dpp v26, v48, v6 row_newbcast:3 row_mask:0xf bank_mask:0xf
  v_and_b32_dpp v27, v48, v7 row_newbcast:3 row_mask:0xf bank_mask:0xf
  v_mfma_f32_16x16x32_bf16 v[72:75], v[20:23], v[144:147], v[72:75]
  v_mfma_f32_16x16x32_bf16 v[76:79], v[20:23], v[148:151], v[76:79]
  v_mfma_f32_16x16x32_bf16 v[80:83], v[20:23], v[152:155], v[80:83]
  v_mfma_f32_16x16x32_bf16 v[64:67], v[24:27], v[156:159], v[64:67]
  v_and_b32_dpp v20, v48, v4 row_newbcast:4 row_mask:0xf bank_mask:0xf
  v_and_b32_dpp v21, v48, v5 row_newbcast:4 row_mask:0xf bank_mask:0xf
  v_mfma_f32_16x16x32_bf16 v[68:71], v[24:27], v[160:163], v[68:71]
  v_and_b32_dpp v22, v48, v6 row_newbcast:4 row_mask:0xf bank_mask:0xf
  v_and_b32_dpp v23, v48, v7 row_newbcast:4 row_mask:0xf bank_mask:0xf
  v_mfma_f32_16x16x32_bf16 v[72:75], v[24:27], v[164:167], v[72:75]
  v_mfma_f32_16x16x32_bf16 v[76:79], v[24:27], v[168:171], v[76:79]
  v_mfma_f32_16x16x32_bf16 v[80:83], v[24:27], v[172:175], v[80:83]
  v_mfma_f32_16x16x32_bf16 v[64:67], v[20:23], v[176:179], v[64:67]
  v_and_b32_dpp v24, v48, v4 row_newbcast:5 row_mask:0xf bank_mask:0xf
  v_and_b32_dpp v25, v48, v5 row_newbcast:5 row_mask:0xf bank_mask:0xf
  v_mfma_f32_16x16x32_bf16 v[68:71], v[20:23], v[180:183], v[68:71]
  v_and_b32_dpp v26, v48, v6 row_newbcast:5 row_mask:0xf bank_mask:0xf
  v_and_b32_dpp v27, v48, v7 row_newbcast:5 row_mask:0xf bank_mask:0xf
  v_mfma_f32_16x16x32_bf16 v[72:75], v[20:23], v[184:187], v[72:75]
  v_and_b32_dpp v16, v48, v4 row_newbcast:7 row_mask:0xf bank_mask:0xf
  v_and_b32_dpp v17, v48, v5 row_newbcast:7 row_mask:0xf bank_mask:0xf
  v_mfma_f32_16x16x32_bf16 v[76:79], v[20:23], v[188:191], v[76:79]
  v_and_b32_dpp v18, v48, v6 row_newbcast:7 row_mask:0xf bank_mask:0xf
  v_and_b32_dpp v19, v48, v7 row_newbcast:7 row_mask:0xf bank_mask:0xf
  v_mfma_f32_16x16x32_bf16 v[80:83], v[20:23], v[192:195], v[80:83]
  v_and_b32_dpp v20, v48, v4 row_newbcast:6 row_mask:0xf bank_mask:0xf
  v_and_b32_dpp v21, v48, v5 row_newbcast:6 row_mask:0xf bank_mask:0xf
  v_and_b32_dpp v22, v48, v6 row_newbcast:6 row_mask:0xf bank_mask:0xf
  v_and_b32_dpp v23, v48, v7 row_newbcast:6 row_mask:0xf bank_mask:0xf
  v_mfma_f32_16x16x32_bf16 v[64:67], v[24:27], v[196:199], v[64:67]
  v_mfma_f32_16x16x32_bf16 v[64:67], v[16:19], v[236:239], v[64:67]
  v_mfma_f32_16x16x32_bf16 v[64:67], v[20:23], v[216:219], v[64:67]
  v_mfma_f32_16x16x32_bf16 v[68:71], v[24:27], v[200:203], v[68:71]
  v_mfma_f32_16x16x32_bf16 v[68:71], v[16:19], v[240:243], v[68:71]
  v_mfma_f32_16x16x32_bf16 v[68:71], v[20:23], v[220:223], v[68:71]
  v_mfma_f32_16x16x32_bf16 v[72:75], v[24:27], v[204:207], v[72:75]
  v_mfma_f32_16x16x32_bf16 v[72:75], v[16:19], v[244:247], v[72:75]
  v_mfma_f32_16x16x32_bf16 v[72:75], v[20:23], v[224:227], v[72:75]
  s_nop 1
  ds_write_b128 v41, v[64:67] offset:4096
  v_mfma_f32_16x16x32_bf16 v[76:79], v[24:27], v[208:211], v[76:79]
  v_mfma_f32_16x16x32_bf16 v[76:79], v[16:19], v[248:251], v[76:79]
  v_mfma_f32_16x16x32_bf16 v[76:79], v[20:23], v[228:231], v[76:79]
  ds_write_b128 v41, v[68:71] offset:5120
  v_mfma_f32_16x16x32_bf16 v[80:83], v[24:27], v[212:215], v[80:83]
  v_mfma_f32_16x16x32_bf16 v[80:83], v[16:19], v[252:255], v[80:83]
  v_mfma_f32_16x16x32_bf16 v[80:83], v[20:23], v[232:235], v[80:83]
  ds_write_b128 v41, v[72:75] offset:6144
  s_nop 2
  ds_write_b128 v41, v[76:79] offset:7168
  s_nop 2
  ds_write_b128 v41, v[80:83] offset:8192
  s_waitcnt lgkmcnt(0)
  s_barrier
  s_cmp_eq_u32 s68, 3
  s_cbranch_scc1 L_cons
  ds_read_b128 v[48:51], v38 offset:4096
  ds_read_b128 v[52:55], v38 offset:9216
  ds_read_b128 v[56:59], v38 offset:14336
  ds_read_b128 v[60:63], v38 offset:19456
  s_waitcnt lgkmcnt(2)
  v_add_f32 v48, v48, v52
  v_add_f32 v49, v49, v53
  v_add_f32 v50, v50, v54
  v_add_f32 v51, v51, v55
  s_waitcnt lgkmcnt(0)
  v_add_f32 v56, v56, v60
  v_add_f32 v57, v57, v61
  v_add_f32 v58, v58, v62
  v_add_f32 v59, v59, v63
  v_add_f32 v48, v48, v56
  v_add_f32 v49, v49, v57
  v_add_f32 v50, v50, v58
  v_add_f32 v51, v51, v59
  v_min_u32 v48, 0xfffffffe, v48
  v_min_u32 v49, 0xfffffffe, v49
  v_min_u32 v50, 0xfffffffe, v50
  v_min_u32 v51, 0xfffffffe, v51
  buffer_store_dwordx4 v[48:51], v42, s[52:55], 0 offen sc1
  s_branch L_fin
L_cons:
  s_cmp_ge_u32 s99, 80
  s_cbranch_scc1 L_fin
  s_mov_b32 s94, 0
  s_waitcnt vmcnt(0)
  s_nop 5
  buffer_load_dword v128, v8, s[52:55], s98 offen sc1
  buffer_load_dwordx4 v[96:99], v1, s[52:55], s96 offen offset:0 sc1
  buffer_load_dwordx4 v[100:103], v1, s[52:55], s96 offen offset:1024 sc1
  buffer_load_dwordx4 v[104:107], v1, s[52:55], s96 offen offset:2048 sc1
  buffer_load_dwordx4 v[108:111], v1, s[52:55], s96 offen offset:3072 sc1
  buffer_load_dwordx4 v[112:115], v1, s[52:55], s97 offen offset:0 sc1
  buffer_load_dwordx4 v[116:119], v1, s[52:55], s97 offen offset:1024 sc1
  buffer_load_dwordx4 v[120:123], v1, s[52:55], s97 offen offset:2048 sc1
  buffer_load_dwordx4 v[124:127], v1, s[52:55], s97 offen offset:3072 sc1
L_poll:
  s_add_u32 s94, s94, 1
  s_cmp_gt_u32 s94, 0x40000
  s_cbranch_scc1 L_fin
  buffer_load_dword v168, v8, s[52:55], s98 offen sc1
  buffer_load_dwordx4 v[136:139], v1, s[52:55], s96 offen offset:0 sc1
  buffer_load_dwordx4 v[140:143], v1, s[52:55], s96 offen offset:1024 sc1
  buffer_load_dwordx4 v[144:147], v1, s[52:55], s96 offen offset:2048 sc1
  buffer_load_dwordx4 v[148:151], v1, s[52:55], s96 offen offset:3072 sc1
  buffer_load_dwordx4 v[152:155], v1, s[52:55], s97 offen offset:0 sc1
  buffer_load_dwordx4 v[156:159], v1, s[52:55], s97 offen offset:1024 sc1
  buffer_load_dwordx4 v[160:163], v1, s[52:55], s97 offen offset:2048 sc1
  buffer_load_dwordx4 v[164:167], v1, s[52:55], s97 offen offset:3072 sc1
  s_waitcnt vmcnt(17)
  v_mov_b32_dpp v47, v128 quad_perm:[1,0,3,2] row_mask:0xf bank_mask:0xf
  v_sub_f32 v47, v47, v128
  v_exp_f32 v47, v47
  s_nop 0
  v_add_f32 v47, 1.0, v47
  v_rcp_f32 v47, v47
  s_nop 0
  ds_bpermute_b32 v48, v9, v47 offset:0
  ds_bpermute_b32 v49, v9, v47 offset:32
  ds_bpermute_b32 v50, v9, v47 offset:64
  ds_bpermute_b32 v51, v9, v47 offset:96
  ds_bpermute_b32 v52, v9, v47 offset:128
  ds_bpermute_b32 v53, v9, v47 offset:160
  ds_bpermute_b32 v54, v9, v47 offset:192
  ds_bpermute_b32 v55, v9, v47 offset:224
  s_waitcnt vmcnt(16) lgkmcnt(7)
  v_max3_u32 v12, v128, v96, v97
  v_max3_u32 v12, v12, v98, v99
  v_mul_f32 v28, v48, v96
  v_mul_f32 v29, v48, v97
  v_mul_f32 v30, v48, v98
  v_mul_f32 v31, v48, v99
  s_waitcnt vmcnt(15) lgkmcnt(6)
  v_max3_u32 v12, v12, v100, v101
  v_max3_u32 v12, v12, v102, v103
  v_fmac_f32 v28, v49, v100
  v_fmac_f32 v29, v49, v101
  v_fmac_f32 v30, v49, v102
  v_fmac_f32 v31, v49, v103
  s_waitcnt vmcnt(14) lgkmcnt(5)
  v_max3_u32 v12, v12, v104, v105
  v_max3_u32 v12, v12, v106, v107
  v_fmac_f32 v28, v50, v104
  v_fmac_f32 v29, v50, v105
  v_fmac_f32 v30, v50, v106
  v_fmac_f32 v31, v50, v107
  s_waitcnt vmcnt(13) lgkmcnt(4)
  v_max3_u32 v12, v12, v108, v109
  v_max3_u32 v12, v12, v110, v111
  v_fmac_f32 v28, v51, v108
  v_fmac_f32 v29, v51, v109
  v_fmac_f32 v30, v51, v110
  v_fmac_f32 v31, v51, v111
  s_waitcnt vmcnt(12) lgkmcnt(3)
  v_max3_u32 v12, v12, v112, v113
  v_max3_u32 v12, v12, v114, v115
  v_fmac_f32 v28, v52, v112
  v_fmac_f32 v29, v52, v113
  v_fmac_f32 v30, v52, v114
  v_fmac_f32 v31, v52, v115
  s_waitcnt vmcnt(11) lgkmcnt(2)
  v_max3_u32 v12, v12, v116, v117
  v_max3_u32 v12, v12, v118, v119
  v_fmac_f32 v28, v53, v116
  v_fmac_f32 v29, v53, v117
  v_fmac_f32 v30, v53, v118
  v_fmac_f32 v31, v53, v119
  s_waitcnt vmcnt(10) lgkmcnt(1)
  v_max3_u32 v12, v12, v120, v121
  v_max3_u32 v12, v12, v122, v123
  v_fmac_f32 v28, v54, v120
  v_fmac_f32 v29, v54, v121
  v_fmac_f32 v30, v54, v122
  v_fmac_f32 v31, v54, v123
  s_waitcnt vmcnt(9) lgkmcnt(0)
  v_max3_u32 v12, v12, v124, v125
  v_max3_u32 v12, v12, v126, v127
  v_fmac_f32 v28, v55, v124
  v_fmac_f32 v29, v55, v125
  v_fmac_f32 v30, v55, v126
  v_fmac_f32 v31, v55, v127
  v_cmp_eq_u32 vcc, -1, v12
  s_cbranch_vccz L_pdone
  buffer_load_dword v128, v8, s[52:55], s98 offen sc1
  buffer_load_dwordx4 v[96:99], v1, s[52:55], s96 offen offset:0 sc1
  buffer_load_dwordx4 v[100:103], v1, s[52:55], s96 offen offset:1024 sc1
  buffer_load_dwordx4 v[104:107], v1, s[52:55], s96 offen offset:2048 sc1
  buffer_load_dwordx4 v[108:111], v1, s[52:55], s96 offen offset:3072 sc1
  buffer_load_dwordx4 v[112:115], v1, s[52:55], s97 offen offset:0 sc1
  buffer_load_dwordx4 v[116:119], v1, s[52:55], s97 offen offset:1024 sc1
  buffer_load_dwordx4 v[120:123], v1, s[52:55], s97 offen offset:2048 sc1
  buffer_load_dwordx4 v[124:127], v1, s[52:55], s97 offen offset:3072 sc1
  s_waitcnt vmcnt(17)
  v_mov_b32_dpp v47, v168 quad_perm:[1,0,3,2] row_mask:0xf bank_mask:0xf
  v_sub_f32 v47, v47, v168
  v_exp_f32 v47, v47
  s_nop 0
  v_add_f32 v47, 1.0, v47
  v_rcp_f32 v47, v47
  s_nop 0
  ds_bpermute_b32 v48, v9, v47 offset:0
  ds_bpermute_b32 v49, v9, v47 offset:32
  ds_bpermute_b32 v50, v9, v47 offset:64
  ds_bpermute_b32 v51, v9, v47 offset:96
  ds_bpermute_b32 v52, v9, v47 offset:128
  ds_bpermute_b32 v53, v9, v47 offset:160
  ds_bpermute_b32 v54, v9, v47 offset:192
  ds_bpermute_b32 v55, v9, v47 offset:224
  s_waitcnt vmcnt(16) lgkmcnt(7)
  v_max3_u32 v12, v168, v136, v137
  v_max3_u32 v12, v12, v138, v139
  v_mul_f32 v28, v48, v136
  v_mul_f32 v29, v48, v137
  v_mul_f32 v30, v48, v138
  v_mul_f32 v31, v48, v139
  s_waitcnt vmcnt(15) lgkmcnt(6)
  v_max3_u32 v12, v12, v140, v141
  v_max3_u32 v12, v12, v142, v143
  v_fmac_f32 v28, v49, v140
  v_fmac_f32 v29, v49, v141
  v_fmac_f32 v30, v49, v142
  v_fmac_f32 v31, v49, v143
  s_waitcnt vmcnt(14) lgkmcnt(5)
  v_max3_u32 v12, v12, v144, v145
  v_max3_u32 v12, v12, v146, v147
  v_fmac_f32 v28, v50, v144
  v_fmac_f32 v29, v50, v145
  v_fmac_f32 v30, v50, v146
  v_fmac_f32 v31, v50, v147
  s_waitcnt vmcnt(13) lgkmcnt(4)
  v_max3_u32 v12, v12, v148, v149
  v_max3_u32 v12, v12, v150, v151
  v_fmac_f32 v28, v51, v148
  v_fmac_f32 v29, v51, v149
  v_fmac_f32 v30, v51, v150
  v_fmac_f32 v31, v51, v151
  s_waitcnt vmcnt(12) lgkmcnt(3)
  v_max3_u32 v12, v12, v152, v153
  v_max3_u32 v12, v12, v154, v155
  v_fmac_f32 v28, v52, v152
  v_fmac_f32 v29, v52, v153
  v_fmac_f32 v30, v52, v154
  v_fmac_f32 v31, v52, v155
  s_waitcnt vmcnt(11) lgkmcnt(2)
  v_max3_u32 v12, v12, v156, v157
  v_max3_u32 v12, v12, v158, v159
  v_fmac_f32 v28, v53, v156
  v_fmac_f32 v29, v53, v157
  v_fmac_f32 v30, v53, v158
  v_fmac_f32 v31, v53, v159
  s_waitcnt vmcnt(10) lgkmcnt(1)
  v_max3_u32 v12, v12, v160, v161
  v_max3_u32 v12, v12, v162, v163
  v_fmac_f32 v28, v54, v160
  v_fmac_f32 v29, v54, v161
  v_fmac_f32 v30, v54, v162
  v_fmac_f32 v31, v54, v163
  s_waitcnt vmcnt(9) lgkmcnt(0)
  v_max3_u32 v12, v12, v164, v165
  v_max3_u32 v12, v12, v166, v167
  v_fmac_f32 v28, v55, v164
  v_fmac_f32 v29, v55, v165
  v_fmac_f32 v30, v55, v166
  v_fmac_f32 v31, v55, v167
  v_cmp_eq_u32 vcc, -1, v12
  s_cbranch_vccz L_pdone
  s_branch L_poll
L_pdone:
  v_permlane32_swap_b32 v28, v29
  v_permlane32_swap_b32 v30, v31
  v_add_f32 v28, v28, v29
  v_add_f32 v30, v30, v31
  s_nop 1
  v_permlane16_swap_b32 v28, v30
  v_add_f32 v28, v28, v30
  s_nop 1
  v_add_f32_dpp v28, v28, v28 row_ror:8 row_mask:0xf bank_mask:0xf
  v_cvt_pk_bf16_f32 v28, v28, v28
  buffer_store_short v28, v10, s[56:59], s65 offen
L_fin:
L_end:
  s_endpgm
.section .rodata,"a"
.p2align 6
.amdhsa_kernel concat_heads__gqa_block_cached__gqa_block_cached__decode_kernel
  .amdhsa_next_free_vgpr 256
  .amdhsa_next_free_sgpr 102
  .amdhsa_accum_offset 256
  .amdhsa_group_segment_fixed_size 0
  .amdhsa_kernarg_size 104
  .amdhsa_user_sgpr_count 2
  .amdhsa_user_sgpr_kernarg_segment_ptr 1
  .amdhsa_system_sgpr_workgroup_id_x 1
  .amdhsa_float_denorm_mode_32 3
.end_amdhsa_kernel
```
